```python
import torch

def _softmax(x, axis=-1):
    return torch.softmax(x, dim=axis)
def _gelu(x):
    return torch.nn.functional.gelu(x, approximate="tanh")
def _silu(x):
    return torch.nn.functional.silu(x)
def _sigmoid(x):
    return torch.sigmoid(x)
def _layernorm(x, axis=-1, eps=1e-5):
    m = x.mean(dim=axis, keepdim=True)
    v = x.var(dim=axis, keepdim=True, unbiased=False)
    return (x - m) / torch.sqrt(v + eps)
def _scatter_add(tgt, idx, src, axis=0):
    return tgt.clone().index_add_(axis, idx, src)
def _segment_sum(src, seg, n):
    out = torch.zeros((n,) + src.shape[1:], dtype=src.dtype)
    return out.index_add_(0, seg, src)
def _pad(x, pw):
    flat = tuple(v for pair in reversed(pw) for v in pair)
    return torch.nn.functional.pad(x, flat)

kernel_name = 'interleave_layers__sliding_block_cached__glu_gated_glu__decode'

def setup_inputs():

    _w = (lambda a: (lambda t: t.to(torch.bfloat16) if t.is_floating_point() else t)(torch.as_tensor(a)))
    def _A_setup():
        B, Sq, D = 4, 1, 512
        Hq, Hkv, Sk, Dh = 32, 8, 8192, 128
        assert Hq % Hkv == 0, (Hq, Hkv)
        return {
            "x": _w((lambda *s: torch.randn(*s, dtype=torch.bfloat16) * 0.05)(B, Sq, D)),
            "k_cache": _w((lambda *s: torch.randn(*s, dtype=torch.bfloat16) * 1.6)(B, Hkv, Sk, Dh)),
            "v_cache": _w((lambda *s: torch.randn(*s, dtype=torch.bfloat16) * 1.6)(B, Hkv, Sk, Dh)),
            "wq": _w((lambda *s: torch.randn(*s, dtype=torch.bfloat16) * 1.6)(D, Hq * Dh) * (D ** -0.5)),
            "wo": _w((lambda *s: torch.randn(*s, dtype=torch.bfloat16) * 1.6)(Hq * Dh, D) * ((Hq * Dh) ** -0.5)),
        }
    _A_in = _A_setup()

    def _B_setup():
        B, S, D, F = 4, 1, 512, 1792
        return {
            "x": _w((lambda *s: torch.randn(*s, dtype=torch.bfloat16) * 0.05)(B, S, D)),
            "w_gate": _w((lambda *s: torch.randn(*s, dtype=torch.bfloat16) * 0.05)(D, F)),
            "w_up": _w((lambda *s: torch.randn(*s, dtype=torch.bfloat16) * 0.05)(D, F)),
            "w_down": _w((lambda *s: torch.randn(*s, dtype=torch.bfloat16) * 0.05)(F, D)),
        }
    _B_in = _B_setup()

    return {
        "A_x": _A_in["x"],
        "A_k_cache": _A_in["k_cache"],
        "A_v_cache": _A_in["v_cache"],
        "A_wq": _A_in["wq"],
        "A_wo": _A_in["wo"],
        "B_x": _B_in["x"],
        "B_w_gate": _B_in["w_gate"],
        "B_w_up": _B_in["w_up"],
        "B_w_down": _B_in["w_down"],
    }

def reference(A_x, A_k_cache, A_v_cache, A_wq, A_wo, B_x, B_w_gate, B_w_up, B_w_down):
    def _A_ref(x, k_cache, v_cache, wq, wo):
        B, Sq, D = x.shape
        Hq, Dh = 32, 128
        Hkv, Sk = k_cache.shape[1], k_cache.shape[2]
        W = min(4096, max(256, Sk // 4))
        rep = Hq // Hkv
        q = (lambda x, *d: x.permute(*d))((x @ wq).reshape(B, Sq, Hq, Dh), 0, 2, 1, 3)
        k = (lambda x, n, axis: torch.repeat_interleave(x, n, dim=axis))(k_cache[:, :, Sk - W:, :], rep, axis=1)
        v = (lambda x, n, axis: torch.repeat_interleave(x, n, dim=axis))(v_cache[:, :, Sk - W:, :], rep, axis=1)
        scores = torch.einsum("bhqd,bhkd->bhqk", q, k) * (Dh ** -0.5)
        p = _softmax(scores, axis=-1)
        o = torch.einsum("bhqk,bhkd->bhqd", p, v)
        return (lambda x, *d: x.permute(*d))(o, 0, 2, 1, 3).reshape(B, Sq, Hq * Dh) @ wo

    def _B_ref(x, w_gate, w_up, w_down):
        g = torch.einsum("bsd,df->bsf", x, w_gate)
        u = torch.einsum("bsd,df->bsf", x, w_up)
        h = _sigmoid(g) * u
        return torch.einsum("bsf,fd->bsd", h, w_down)

    x = A_x
    x = x + _A_ref(_layernorm(x, axis=-1), A_k_cache, A_v_cache, A_wq, A_wo)
    x = x + _B_ref(_layernorm(x, axis=-1), B_w_gate, B_w_up, B_w_down)
    x = x + _A_ref(_layernorm(x, axis=-1), A_k_cache, A_v_cache, A_wq, A_wo)
    x = x + _B_ref(_layernorm(x, axis=-1), B_w_gate, B_w_up, B_w_down)
    return x
```

```asm
; @launch grid=(256,1,1) block=(256,1,1) lds=148480
.amdgcn_target "amdgcn-amd-amdhsa--gfx950"
.text
.globl interleave_layers__sliding_block_cached__glu_gated_glu__decode_kernel
.p2align 8
.type interleave_layers__sliding_block_cached__glu_gated_glu__decode_kernel,@function
interleave_layers__sliding_block_cached__glu_gated_glu__decode_kernel:
s_cmp_ge_u32 s2, 256
s_cbranch_scc1 L_end
s_load_dwordx16 s[8:23], s[0:1], 0
s_load_dwordx8 s[24:31], s[0:1], 64
s_getpc_b64 s[48:49]
L_pc:
v_lshlrev_b32 v31, 4, v0
s_sub_u32 s48, s48, L_pc-interleave_layers__sliding_block_cached__glu_gated_glu__decode_kernel
s_subb_u32 s49, s49, 0
global_load_dwordx4 v[160:163], v31, s[48:49]
v_lshrrev_b32 v30, 6, v0
v_and_b32 v0, 63, v0
s_and_b32 s3, s2, 7
s_lshr_b32 s38, s2, 3
s_lshr_b32 s4, s38, 3
s_and_b32 s5, s38, 7
v_readfirstlane_b32 s6, v30
s_lshl_b32 s57, s3, 2
s_add_u32 s57, s57, s4
v_lshrrev_b32 v42, 3, v0
v_and_b32 v43, 7, v0
v_bfe_u32 v44, v0, 4, 1
v_lshlrev_b32 v44, 1, v44
v_xor_b32 v43, v43, v44
v_lshlrev_b32 v43, 4, v43
v_lshl_add_u32 v140, v42, 13, v43
v_xor_b32 v141, 64, v140
s_mov_b32 s34, 4194304
s_mov_b32 s35, 0x20000
s_lshl_b32 s59, s3, 10
s_lshl_b32 s38, s5, 7
s_add_u32 s59, s59, s38
s_lshl_b32 s38, s6, 20
s_add_u32 s59, s59, s38
v_mov_b32 v32, 0
v_mov_b32 v33, 0
v_mov_b32 v34, 0
v_mov_b32 v35, 0
v_mov_b32 v36, 0
v_mov_b32 v37, 0
v_mov_b32 v38, 0
v_mov_b32 v39, 0
s_mov_b32 s40, 0x00030003
s_mov_b32 s41, 0x00030003
v_lshrrev_b32 v47, 4, v0
v_and_b32 v54, 1, v0
v_lshlrev_b32 v54, 2, v54
v_add_u32 v54, v54, v47
v_lshlrev_b32 v54, 4, v54
s_lshl_b32 s64, s4, 10
s_lshl_b32 s39, s6, 8
s_add_u32 s39, s64, s39
v_add_u32 v54, s39, v54
v_lshlrev_b32 v55, 4, v0
v_add_u32 v55, s64, v55
s_waitcnt lgkmcnt(0)
s_lshl_b32 s19, s6, 14
s_mov_b32 s32, s14
s_and_b32 s33, s15, 0xffff
s_mov_b64 exec, s[40:41]
global_load_dwordx4 v[32:35], v54, s[8:9]
global_load_dwordx4 v[36:39], v54, s[8:9] offset:128
s_mov_b64 exec, -1
global_load_dwordx4 v[72:75], v55, s[8:9]
s_add_u32 s38, s4, 0
s_and_b32 s38, s38, 3
s_mul_i32 s39, s38, 262144
s_add_u32 s36, s39, s59
s_lshl_b32 s38, s38, 12
s_add_u32 s38, s38, s19
s_add_u32 m0, s38, 0
s_nop 0
buffer_load_dwordx4 v140, s[32:35], s36 offen nt lds
s_add_u32 m0, m0, 1024
s_add_u32 s36, s36, 65536
buffer_load_dwordx4 v141, s[32:35], s36 offen nt lds
s_add_u32 m0, m0, 1024
s_add_u32 s36, s36, 65536
buffer_load_dwordx4 v140, s[32:35], s36 offen nt lds
s_add_u32 m0, m0, 1024
s_add_u32 s36, s36, 65536
buffer_load_dwordx4 v141, s[32:35], s36 offen nt lds
s_add_u32 s38, s4, 1
s_and_b32 s38, s38, 3
s_mul_i32 s39, s38, 262144
s_add_u32 s36, s39, s59
s_lshl_b32 s38, s38, 12
s_add_u32 s38, s38, s19
s_add_u32 m0, s38, 0
s_nop 0
buffer_load_dwordx4 v140, s[32:35], s36 offen nt lds
s_add_u32 m0, m0, 1024
s_add_u32 s36, s36, 65536
buffer_load_dwordx4 v141, s[32:35], s36 offen nt lds
s_add_u32 m0, m0, 1024
s_add_u32 s36, s36, 65536
buffer_load_dwordx4 v140, s[32:35], s36 offen nt lds
s_add_u32 m0, m0, 1024
s_add_u32 s36, s36, 65536
buffer_load_dwordx4 v141, s[32:35], s36 offen nt lds
s_add_u32 s38, s4, 2
s_and_b32 s38, s38, 3
s_mul_i32 s39, s38, 262144
s_add_u32 s36, s39, s59
s_lshl_b32 s38, s38, 12
s_add_u32 s38, s38, s19
s_add_u32 m0, s38, 0
s_nop 0
buffer_load_dwordx4 v140, s[32:35], s36 offen nt lds
s_add_u32 m0, m0, 1024
s_add_u32 s36, s36, 65536
buffer_load_dwordx4 v141, s[32:35], s36 offen nt lds
s_add_u32 m0, m0, 1024
s_add_u32 s36, s36, 65536
buffer_load_dwordx4 v140, s[32:35], s36 offen nt lds
s_add_u32 m0, m0, 1024
s_add_u32 s36, s36, 65536
buffer_load_dwordx4 v141, s[32:35], s36 offen nt lds
s_add_u32 s38, s4, 3
s_and_b32 s38, s38, 3
s_mul_i32 s39, s38, 262144
s_add_u32 s36, s39, s59
s_lshl_b32 s38, s38, 12
s_add_u32 s38, s38, s19
s_add_u32 m0, s38, 0
s_nop 0
buffer_load_dwordx4 v140, s[32:35], s36 offen nt lds
s_add_u32 m0, m0, 1024
s_add_u32 s36, s36, 65536
buffer_load_dwordx4 v141, s[32:35], s36 offen nt lds
s_add_u32 m0, m0, 1024
s_add_u32 s36, s36, 65536
buffer_load_dwordx4 v140, s[32:35], s36 offen nt lds
s_add_u32 m0, m0, 1024
s_add_u32 s36, s36, 65536
buffer_load_dwordx4 v141, s[32:35], s36 offen nt lds
s_cmp_lg_u32 s6, 3
s_cbranch_scc1 Lw_1
s_lshl_b32 s39, s5, 7
s_add_u32 s38, s64, s39
v_lshlrev_b32 v55, 1, v0
v_add_u32 v55, s38, v55
global_load_ushort v17, v55, s[8:9]
s_lshl_b32 s38, s2, 12
v_lshlrev_b32 v55, 4, v0
v_add_u32 v55, s38, v55
v_mov_b32 v56, -1
v_mov_b32 v57, -1
v_mov_b32 v58, -1
v_mov_b32 v59, -1
global_store_dwordx4 v55, v[56:59], s[30:31] offset:0 sc1
global_store_dwordx4 v55, v[56:59], s[30:31] offset:1024 sc1
global_store_dwordx4 v55, v[56:59], s[30:31] offset:2048 sc1
global_store_dwordx4 v55, v[56:59], s[30:31] offset:3072 sc1
s_and_b32 s39, s5, 1
s_lshl_b32 s39, s39, 6
v_add_u32 v60, s39, v0
v_lshrrev_b32 v61, 5, v60
v_lshlrev_b32 v61, 8, v61
v_bfe_u32 v6, v60, 3, 2
v_lshl_add_u32 v61, v6, 6, v61
v_and_b32 v60, 7, v60
v_lshl_add_u32 v61, v60, 1, v61
s_lshl_b32 s38, s57, 10
s_lshr_b32 s39, s5, 1
s_lshl_b32 s39, s39, 4
s_add_u32 s38, s38, s39
v_add_u32 v6, s38, v61
s_add_u32 s66, s30, 1048576
s_addc_u32 s67, s31, 0
s_mov_b32 s50, 0x55555555
s_mov_b32 s51, 0x55555555
s_mov_b64 exec, s[50:51]
global_store_dword v6, v56, s[66:67] sc1
s_mov_b64 exec, -1
Lw_1:
s_cmp_lg_u32 s6, 2
s_cbranch_scc1 Lw_2
s_lshr_b32 s38, s2, 3
s_lshl_b32 s38, s38, 11
s_add_u32 s38, s38, 4096
v_lshlrev_b32 v55, 4, v0
v_add_u32 v55, s38, v55
s_mov_b32 s39, L_text_end-interleave_layers__sliding_block_cached__glu_gated_glu__decode_kernel-1024-16
v_min_u32 v55, s39, v55
global_load_dwordx4 v[164:167], v55, s[48:49]
global_load_dwordx4 v[168:171], v55, s[48:49] offset:1024
Lw_2:
v_lshrrev_b32 v42, 3, v0
v_and_b32 v43, 7, v0
v_bfe_u32 v44, v0, 4, 1
v_lshlrev_b32 v44, 1, v44
v_xor_b32 v43, v43, v44
v_lshlrev_b32 v43, 4, v43
v_lshl_add_u32 v140, v42, 13, v43
v_xor_b32 v141, 64, v140
v_lshrrev_b32 v47, 4, v0
v_and_b32 v48, 15, v0
v_xor_b32 v49, v48, v47
v_lshlrev_b32 v49, 4, v49
v_lshl_add_u32 v142, v47, 8, v49
v_xor_b32 v143, 64, v142
v_xor_b32 v144, 128, v142
v_xor_b32 v145, 192, v142
s_mov_b32 s96, s10
s_and_b32 s97, s11, 0xffff
s_mov_b32 s98, 67108864
s_mov_b32 s99, 0x20000
s_lshl_b32 s37, s4, 24
s_lshl_b32 s38, s3, 21
s_add_u32 s37, s37, s38
s_lshl_b32 s38, s5, 16
s_add_u32 s37, s37, s38
s_add_u32 s37, s37, 1572864
s_add_u32 s37, s37, s19
v_lshrrev_b32 v42, 3, v0
v_and_b32 v43, 7, v0
v_bfe_u32 v44, v0, 4, 1
v_lshlrev_b32 v44, 1, v44
v_xor_b32 v43, v43, v44
v_lshlrev_b32 v43, 4, v43
v_lshl_add_u32 v148, v42, 10, v43
v_xor_b32 v149, 64, v148
v_lshrrev_b32 v47, 4, v0
v_and_b32 v48, 15, v0
v_lshlrev_b32 v49, 1, v47
v_xor_b32 v49, v48, v49
v_lshlrev_b32 v49, 4, v49
v_lshl_add_u32 v146, v47, 8, v49
v_xor_b32 v147, 128, v146
s_mov_b32 s42, 0x00030003
s_mov_b32 s43, 0x00010003
s_mov_b32 s44, 0x000f000f
s_mov_b32 s45, 0x000f000f
s_mov_b32 s50, 0x55555555
s_mov_b32 s51, 0x55555555
s_mov_b32 s52, 0xaaaaaaaa
s_mov_b32 s53, 0xaaaaaaaa
s_mov_b32 s54, 0x55555555
s_mov_b32 s55, 0x00000000
s_mov_b32 s60, 0x00000001
s_mov_b32 s61, 0x00000001
s_mov_b32 s62, 0x0000000f
s_mov_b32 s63, 0x00000000
s_mov_b32 s18, 0x3e0293ee
s_mov_b32 s78, 0x3e0293ee
s_mov_b32 s79, 0x3e0293ee
s_mov_b32 s77, s5
s_cmp_eq_u32 s5, 3
s_cselect_b32 s77, 7, s77
s_cmp_eq_u32 s5, 7
s_cselect_b32 s77, 3, s77
s_mul_i32 s58, s3, 7
s_add_u32 s58, s58, s77
s_mov_b32 s46, s30
s_mov_b32 s47, s31
v_and_b32 v64, 15, v0
v_lshrrev_b32 v65, 4, v0
v_bfe_u32 v66, v0, 1, 3
v_and_b32 v67, 1, v0
v_mov_b32 v20, 0x3f803f80
v_mov_b32 v21, 0x3f803f80
v_mov_b32 v22, 0x3f803f80
v_mov_b32 v23, 0x3f803f80
v_lshl_add_u32 v68, v67, 2, v65
v_lshlrev_b32 v68, 4, v68
v_lshl_add_u32 v68, v66, 10, v68
s_lshl_b32 s38, s4, 13
s_lshl_b32 s39, s6, 8
s_add_u32 s38, s38, s39
v_add_u32 v1, s38, v68
s_lshl_b32 s38, s57, 13
s_add_u32 s38, s38, s39
v_add_u32 v2, s38, v68
v_lshl_add_u32 v68, v65, 1, v64
v_and_b32 v68, 7, v68
v_lshlrev_b32 v68, 3, v68
s_lshl_b32 s38, s57, 8
s_lshl_b32 s39, s6, 6
s_add_u32 s38, s38, s39
v_add_u32 v3, s38, v68
s_lshl_b32 s39, s5, 3
s_add_u32 s38, s38, s39
v_mov_b32 v8, s38
v_lshl_add_u32 v68, v64, 2, v65
s_mul_i32 s39, s6, 7
v_add_u32 v68, s39, v68
v_lshlrev_b32 v68, 4, v68
s_lshl_b32 s39, s57, 9
v_add_u32 v4, s39, v68
v_lshlrev_b32 v68, 4, v64
v_lshl_add_u32 v68, v65, 6, v68
s_lshl_b32 s38, s57, 10
v_add_u32 v5, s38, v68
s_and_b32 s39, s5, 1
s_lshl_b32 s39, s39, 6
v_add_u32 v68, s39, v0
v_lshrrev_b32 v69, 5, v68
v_lshlrev_b32 v69, 8, v69
v_bfe_u32 v6, v68, 3, 2
v_lshl_add_u32 v69, v6, 6, v69
v_and_b32 v68, 7, v68
v_lshl_add_u32 v69, v68, 1, v69
s_lshl_b32 s38, s57, 10
s_lshr_b32 s39, s5, 1
s_lshl_b32 s39, s39, 4
s_add_u32 s38, s38, s39
v_add_u32 v6, s38, v69
s_lshl_b32 s38, s57, 13
s_lshl_b32 s39, s5, 10
s_add_u32 s38, s38, s39
s_lshl_b32 s39, s6, 8
s_add_u32 s38, s38, s39
v_lshlrev_b32 v68, 2, v0
v_add_u32 v7, s38, v68
s_lshl_b32 s38, s4, 3
s_add_u32 s38, s38, s5
s_lshl_b32 s38, s38, 11
s_lshl_b32 s39, s3, 8
s_add_u32 s38, s38, s39
v_add_u32 v12, s38, v68
s_lshl_b32 s38, s6, 8
s_add_u32 s38, s38, 131072
v_add_u32 v13, s38, v68
v_add_u32 v14, 131072, v68
v_mov_b32 v29, 131072
v_lshlrev_b32 v69, 1, v0
s_lshl_b32 s38, s4, 13
s_lshl_b32 s39, s3, 10
s_add_u32 s38, s38, s39
s_lshl_b32 s39, s5, 7
s_add_u32 s38, s38, s39
v_add_u32 v9, s38, v69
v_mov_b32 v11, v9
s_lshl_b32 s38, s57, 9
s_lshl_b32 s39, s77, 6
s_add_u32 s38, s38, s39
v_add_u32 v10, s38, v69
s_mul_i32 s38, s6, 2112
s_add_u32 s38, s38, 139264
v_and_b32 v69, 3, v64
v_mul_u32_u24 v69, 528, v69
v_lshl_add_u32 v69, v65, 4, v69
v_add_u32 v18, s38, v69
s_mul_i32 s38, s6, 528
s_add_u32 s38, s38, 139264
v_lshlrev_b32 v69, 3, v0
v_add_u32 v19, s38, v69
s_lshl_b32 s38, s6, 3
s_add_u32 s39, s38, 138432
v_and_b32 v69, 3, v64
v_lshlrev_b32 v69, 5, v69
v_add_u32 v25, s39, v69
s_add_u32 s39, s38, 138240
v_lshrrev_b32 v69, 5, v0
v_lshlrev_b32 v69, 2, v69
v_add_u32 v24, s39, v69
s_lshl_b32 s38, s6, 5
s_add_u32 s38, s38, 138432
v_mov_b32 v26, s38
s_lshl_b32 s38, s6, 8
s_add_u32 s38, s38, 136192
v_lshlrev_b32 v69, 4, v64
v_add_u32 v27, s38, v69
v_lshl_add_u32 v69, v65, 2, v69
v_add_u32 v28, 136192, v69
s_waitcnt vmcnt(16)
v_mov_b32 v42, 0
v_mov_b32 v43, 0
v_dot2_f32_bf16 v43, v72, v72, v43
v_dot2_f32_bf16 v42, v72, v20, v42
v_dot2_f32_bf16 v43, v73, v73, v43
v_dot2_f32_bf16 v42, v73, v20, v42
v_dot2_f32_bf16 v43, v74, v74, v43
v_dot2_f32_bf16 v42, v74, v20, v42
v_dot2_f32_bf16 v43, v75, v75, v43
v_dot2_f32_bf16 v42, v75, v20, v42
s_nop 1
v_add_f32_dpp v43, v43, v43 row_ror:8 row_mask:0xf bank_mask:0xf
v_add_f32_dpp v42, v42, v42 row_ror:8 row_mask:0xf bank_mask:0xf
s_nop 0
v_add_f32_dpp v43, v43, v43 row_ror:4 row_mask:0xf bank_mask:0xf
v_add_f32_dpp v42, v42, v42 row_ror:4 row_mask:0xf bank_mask:0xf
s_nop 0
v_add_f32_dpp v43, v43, v43 row_ror:2 row_mask:0xf bank_mask:0xf
v_add_f32_dpp v42, v42, v42 row_ror:2 row_mask:0xf bank_mask:0xf
s_nop 0
v_add_f32_dpp v43, v43, v43 row_ror:1 row_mask:0xf bank_mask:0xf
v_add_f32_dpp v42, v42, v42 row_ror:1 row_mask:0xf bank_mask:0xf
s_nop 1
v_permlane32_swap_b32 v43, v42
v_add_f32 v43, v43, v42
v_mov_b32 v44, v43
s_nop 1
v_permlane16_swap_b32 v43, v44
v_add_f32 v43, v43, v44
v_mov_b32 v42, v43
s_nop 1
v_permlane32_swap_b32 v43, v42
v_mul_f32 v42, 0x3b000000, v42
v_mul_f32 v43, 0x3b000000, v43
v_fma_f32 v43, -v42, v42, v43
v_max_f32 v43, 0, v43
v_add_f32 v43, 0x3727c5ac, v43
v_rsq_f32 v43, v43
s_mov_b64 exec, s[40:41]
v_lshlrev_b32 v44, 16, v32
v_and_b32 v45, 0xffff0000, v32
v_sub_f32 v44, v44, v42
v_sub_f32 v45, v45, v42
v_mul_f32 v44, v44, v43
v_mul_f32 v45, v45, v43
v_cvt_pk_bf16_f32 v32, v44, v45
v_lshlrev_b32 v44, 16, v33
v_and_b32 v45, 0xffff0000, v33
v_sub_f32 v44, v44, v42
v_sub_f32 v45, v45, v42
v_mul_f32 v44, v44, v43
v_mul_f32 v45, v45, v43
v_cvt_pk_bf16_f32 v33, v44, v45
v_lshlrev_b32 v44, 16, v34
v_and_b32 v45, 0xffff0000, v34
v_sub_f32 v44, v44, v42
v_sub_f32 v45, v45, v42
v_mul_f32 v44, v44, v43
v_mul_f32 v45, v45, v43
v_cvt_pk_bf16_f32 v34, v44, v45
v_lshlrev_b32 v44, 16, v35
v_and_b32 v45, 0xffff0000, v35
v_sub_f32 v44, v44, v42
v_sub_f32 v45, v45, v42
v_mul_f32 v44, v44, v43
v_mul_f32 v45, v45, v43
v_cvt_pk_bf16_f32 v35, v44, v45
v_lshlrev_b32 v44, 16, v36
v_and_b32 v45, 0xffff0000, v36
v_sub_f32 v44, v44, v42
v_sub_f32 v45, v45, v42
v_mul_f32 v44, v44, v43
v_mul_f32 v45, v45, v43
v_cvt_pk_bf16_f32 v36, v44, v45
v_lshlrev_b32 v44, 16, v37
v_and_b32 v45, 0xffff0000, v37
v_sub_f32 v44, v44, v42
v_sub_f32 v45, v45, v42
v_mul_f32 v44, v44, v43
v_mul_f32 v45, v45, v43
v_cvt_pk_bf16_f32 v37, v44, v45
v_lshlrev_b32 v44, 16, v38
v_and_b32 v45, 0xffff0000, v38
v_sub_f32 v44, v44, v42
v_sub_f32 v45, v45, v42
v_mul_f32 v44, v44, v43
v_mul_f32 v45, v45, v43
v_cvt_pk_bf16_f32 v38, v44, v45
v_lshlrev_b32 v44, 16, v39
v_and_b32 v45, 0xffff0000, v39
v_sub_f32 v44, v44, v42
v_sub_f32 v45, v45, v42
v_mul_f32 v44, v44, v43
v_mul_f32 v45, v45, v43
v_cvt_pk_bf16_f32 v39, v44, v45
s_mov_b64 exec, -1
s_add_u32 m0, s19, 65536
s_add_u32 s36, s37, 0
buffer_load_dwordx4 v142, s[96:99], s36 offen nt lds
s_add_u32 m0, s19, 66560
s_add_u32 s36, s37, 1024
buffer_load_dwordx4 v143, s[96:99], s36 offen nt lds
s_add_u32 m0, s19, 67584
s_add_u32 s36, s37, 2048
buffer_load_dwordx4 v144, s[96:99], s36 offen nt lds
s_add_u32 m0, s19, 68608
s_add_u32 s36, s37, 3072
buffer_load_dwordx4 v145, s[96:99], s36 offen nt lds
s_add_u32 m0, s19, 69632
s_add_u32 s36, s37, 4096
buffer_load_dwordx4 v142, s[96:99], s36 offen nt lds
s_add_u32 m0, s19, 70656
s_add_u32 s36, s37, 5120
buffer_load_dwordx4 v143, s[96:99], s36 offen nt lds
s_add_u32 m0, s19, 71680
s_add_u32 s36, s37, 6144
buffer_load_dwordx4 v144, s[96:99], s36 offen nt lds
s_add_u32 m0, s19, 72704
s_add_u32 s36, s37, 7168
buffer_load_dwordx4 v145, s[96:99], s36 offen nt lds
s_cmp_lg_u32 s6, 3
s_cbranch_scc1 Lw_3
s_getreg_b32 s64, hwreg(HW_REG_XCC_ID, 0, 4)
s_mul_i32 s65, s64, s64
s_lshl_b32 s65, s65, 16
s_or_b32 s65, s65, s64
s_lshl_b32 s38, s57, 3
v_mov_b32 v59, s38
v_mov_b32 v60, 1
v_mov_b32 v61, s65
s_waitcnt vmcnt(8)
s_mov_b64 exec, 1
global_atomic_add_x2 v59, v[60:61], s[28:29] sc1
s_mov_b64 exec, -1
v_lshlrev_b32 v17, 16, v17
s_cmp_eq_u32 s3, 0
s_cbranch_scc1 Lrz_4
v_mov_b32 v17, 0
Lrz_4:
Lw_3:
s_waitcnt vmcnt(8)
v_lshrrev_b32 v46, 4, v0
v_bfe_u32 v47, v0, 2, 2
v_lshl_add_u32 v48, v46, 3, v47
v_lshlrev_b32 v48, 7, v48
v_lshrrev_b32 v49, 1, v47
v_and_b32 v46, 1, v46
v_lshl_or_b32 v49, v46, 1, v49
v_lshlrev_b32 v49, 1, v49
v_bfe_u32 v46, v0, 1, 1
v_xor_b32 v49, v49, v46
v_lshl_add_u32 v48, v49, 4, v48
v_and_b32 v46, 1, v0
v_lshl_add_u32 v48, v46, 3, v48
s_lshl_b32 s68, s6, 14
s_add_u32 s68, s68, 0
v_add_u32 v48, s68, v48
v_xor_b32 v42, 0, v48
v_xor_b32 v43, 32, v48
v_xor_b32 v44, 64, v48
v_xor_b32 v45, 96, v48
ds_read_b64_tr_b16 a[128:129], v42 offset:0
ds_read_b64_tr_b16 a[130:131], v42 offset:512
ds_read_b64_tr_b16 a[132:133], v42 offset:4096
ds_read_b64_tr_b16 a[134:135], v42 offset:4608
ds_read_b64_tr_b16 a[136:137], v42 offset:8192
ds_read_b64_tr_b16 a[138:139], v42 offset:8704
ds_read_b64_tr_b16 a[140:141], v42 offset:12288
ds_read_b64_tr_b16 a[142:143], v42 offset:12800
ds_read_b64_tr_b16 a[144:145], v43 offset:0
ds_read_b64_tr_b16 a[146:147], v43 offset:512
ds_read_b64_tr_b16 a[148:149], v43 offset:4096
ds_read_b64_tr_b16 a[150:151], v43 offset:4608
ds_read_b64_tr_b16 a[152:153], v43 offset:8192
ds_read_b64_tr_b16 a[154:155], v43 offset:8704
ds_read_b64_tr_b16 a[156:157], v43 offset:12288
ds_read_b64_tr_b16 a[158:159], v43 offset:12800
ds_read_b64_tr_b16 a[160:161], v44 offset:0
ds_read_b64_tr_b16 a[162:163], v44 offset:512
ds_read_b64_tr_b16 a[164:165], v44 offset:4096
ds_read_b64_tr_b16 a[166:167], v44 offset:4608
ds_read_b64_tr_b16 a[168:169], v44 offset:8192
ds_read_b64_tr_b16 a[170:171], v44 offset:8704
ds_read_b64_tr_b16 a[172:173], v44 offset:12288
ds_read_b64_tr_b16 a[174:175], v44 offset:12800
ds_read_b64_tr_b16 a[176:177], v45 offset:0
ds_read_b64_tr_b16 a[178:179], v45 offset:512
ds_read_b64_tr_b16 a[180:181], v45 offset:4096
ds_read_b64_tr_b16 a[182:183], v45 offset:4608
ds_read_b64_tr_b16 a[184:185], v45 offset:8192
ds_read_b64_tr_b16 a[186:187], v45 offset:8704
ds_read_b64_tr_b16 a[188:189], v45 offset:12288
ds_read_b64_tr_b16 a[190:191], v45 offset:12800
s_waitcnt lgkmcnt(0)
v_mfma_f32_16x16x32_bf16 v[64:67], v[32:35], a[128:131], 0
v_mfma_f32_16x16x32_bf16 v[68:71], v[32:35], a[132:135], 0
v_mfma_f32_16x16x32_bf16 v[64:67], v[36:39], a[136:139], v[64:67]
v_mfma_f32_16x16x32_bf16 v[68:71], v[36:39], a[140:143], v[68:71]
v_mfma_f32_16x16x32_bf16 v[72:75], v[32:35], a[144:147], 0
v_mfma_f32_16x16x32_bf16 v[76:79], v[32:35], a[148:151], 0
v_mfma_f32_16x16x32_bf16 v[72:75], v[36:39], a[152:155], v[72:75]
v_mfma_f32_16x16x32_bf16 v[76:79], v[36:39], a[156:159], v[76:79]
v_mfma_f32_16x16x32_bf16 v[80:83], v[32:35], a[160:163], 0
s_nop 1
v_add_f32 v54, v64, v66
v_mfma_f32_16x16x32_bf16 v[84:87], v[32:35], a[164:167], 0
v_add_f32 v69, v69, v71
v_add_f32 v54, v54, v69
v_add_f32 v55, v72, v74
v_mfma_f32_16x16x32_bf16 v[80:83], v[36:39], a[168:171], v[80:83]
v_add_f32 v77, v77, v79
v_add_f32 v55, v55, v77
v_mfma_f32_16x16x32_bf16 v[84:87], v[36:39], a[172:175], v[84:87]
v_mfma_f32_16x16x32_bf16 v[88:91], v[32:35], a[176:179], 0
v_mfma_f32_16x16x32_bf16 v[92:95], v[32:35], a[180:183], 0
v_mfma_f32_16x16x32_bf16 v[88:91], v[36:39], a[184:187], v[88:91]
s_nop 1
v_add_f32 v56, v80, v82
v_mfma_f32_16x16x32_bf16 v[92:95], v[36:39], a[188:191], v[92:95]
s_nop 0
v_add_f32 v85, v85, v87
v_add_f32 v56, v56, v85
s_nop 0
v_add_f32 v57, v88, v90
v_permlane32_swap_b32 v54, v56
v_add_f32 v54, v54, v56
s_nop 0
v_add_f32 v93, v93, v95
v_add_f32 v57, v57, v93
s_nop 1
v_permlane32_swap_b32 v55, v57
v_add_f32 v55, v55, v57
s_nop 1
v_permlane16_swap_b32 v54, v55
v_add_f32 v54, v54, v55
ds_write_b32 v13, v54 offset:0
s_waitcnt lgkmcnt(0)
s_barrier
s_cmp_lg_u32 s6, 3
s_cbranch_scc1 Lw_5
ds_read2st64_b32 v[42:43], v14 offset0:0 offset1:1
ds_read2st64_b32 v[44:45], v14 offset0:2 offset1:3
s_add_u32 s48, s30, 1048576
s_addc_u32 s49, s31, 0
s_waitcnt lgkmcnt(0)
v_add_f32 v42, v42, v43
v_add_f32 v44, v44, v45
v_add_f32 v54, v42, v44
s_nop 1
v_mov_b32_dpp v43, v54 quad_perm:[1,1,3,3] row_mask:0xf bank_mask:0xf
v_cvt_pk_bf16_f32 v55, v54, v43
s_mov_b64 exec, s[50:51]
global_store_dword v6, v55, s[48:49] sc1
s_mov_b64 exec, -1
Lw_5:
s_add_u32 m0, s19, 73728
s_add_u32 s36, s37, 8192
buffer_load_dwordx4 v142, s[96:99], s36 offen nt lds
s_add_u32 m0, s19, 74752
s_add_u32 s36, s37, 9216
buffer_load_dwordx4 v143, s[96:99], s36 offen nt lds
s_add_u32 m0, s19, 75776
s_add_u32 s36, s37, 10240
buffer_load_dwordx4 v144, s[96:99], s36 offen nt lds
s_add_u32 m0, s19, 76800
s_add_u32 s36, s37, 11264
buffer_load_dwordx4 v145, s[96:99], s36 offen nt lds
s_add_u32 m0, s19, 77824
s_add_u32 s36, s37, 12288
buffer_load_dwordx4 v142, s[96:99], s36 offen nt lds
s_add_u32 m0, s19, 78848
s_add_u32 s36, s37, 13312
buffer_load_dwordx4 v143, s[96:99], s36 offen nt lds
s_add_u32 m0, s19, 79872
s_add_u32 s36, s37, 14336
buffer_load_dwordx4 v144, s[96:99], s36 offen nt lds
s_add_u32 m0, s19, 80896
s_add_u32 s36, s37, 15360
buffer_load_dwordx4 v145, s[96:99], s36 offen nt lds
s_mov_b32 s32, s16
s_and_b32 s33, s17, 0xffff
s_mov_b32 s34, 4194304
s_mov_b32 s35, 0x20000
s_lshl_b32 s59, s3, 19
s_lshl_b32 s38, s5, 7
s_add_u32 s59, s59, s38
s_lshl_b32 s38, s6, 17
s_add_u32 s59, s59, s38
s_add_u32 s38, s4, 0
s_and_b32 s38, s38, 3
s_mul_i32 s39, s38, 32768
s_add_u32 s36, s39, s59
s_lshl_b32 s38, s38, 12
s_add_u32 s38, s38, s19
s_add_u32 m0, s38, 0
s_nop 0
buffer_load_dwordx4 v148, s[32:35], s36 offen lds
s_add_u32 m0, m0, 1024
s_add_u32 s36, s36, 8192
buffer_load_dwordx4 v149, s[32:35], s36 offen lds
s_add_u32 m0, m0, 1024
s_add_u32 s36, s36, 8192
buffer_load_dwordx4 v148, s[32:35], s36 offen lds
s_add_u32 m0, m0, 1024
s_add_u32 s36, s36, 8192
buffer_load_dwordx4 v149, s[32:35], s36 offen lds
s_add_u32 s38, s4, 1
s_and_b32 s38, s38, 3
s_mul_i32 s39, s38, 32768
s_add_u32 s36, s39, s59
s_lshl_b32 s38, s38, 12
s_add_u32 s38, s38, s19
s_add_u32 m0, s38, 0
s_nop 0
buffer_load_dwordx4 v148, s[32:35], s36 offen lds
s_add_u32 m0, m0, 1024
s_add_u32 s36, s36, 8192
buffer_load_dwordx4 v149, s[32:35], s36 offen lds
s_add_u32 m0, m0, 1024
s_add_u32 s36, s36, 8192
buffer_load_dwordx4 v148, s[32:35], s36 offen lds
s_add_u32 m0, m0, 1024
s_add_u32 s36, s36, 8192
buffer_load_dwordx4 v149, s[32:35], s36 offen lds
s_waitcnt vmcnt(8)
s_add_u32 s38, s4, 2
s_and_b32 s38, s38, 3
s_mul_i32 s39, s38, 32768
s_add_u32 s36, s39, s59
s_lshl_b32 s38, s38, 12
s_add_u32 s38, s38, s19
s_add_u32 m0, s38, 0
s_nop 0
buffer_load_dwordx4 v148, s[32:35], s36 offen lds
v_and_b32 v42, 15, v0
v_lshrrev_b32 v43, 4, v0
v_xor_b32 v44, v42, v43
v_lshlrev_b32 v44, 4, v44
s_add_u32 m0, m0, 1024
s_add_u32 s36, s36, 8192
buffer_load_dwordx4 v149, s[32:35], s36 offen lds
v_lshl_add_u32 v44, v42, 8, v44
s_add_u32 s68, s19, 65536
v_add_u32 v44, s68, v44
s_add_u32 m0, m0, 1024
s_add_u32 s36, s36, 8192
buffer_load_dwordx4 v148, s[32:35], s36 offen lds
v_xor_b32 v46, 0, v44
v_xor_b32 v47, 64, v44
v_xor_b32 v48, 128, v44
v_xor_b32 v49, 192, v44
s_add_u32 m0, m0, 1024
s_add_u32 s36, s36, 8192
buffer_load_dwordx4 v149, s[32:35], s36 offen lds
ds_read_b128 a[0:3], v46 offset:0
ds_read_b128 a[4:7], v47 offset:0
ds_read_b128 a[8:11], v48 offset:0
s_add_u32 s38, s4, 3
s_and_b32 s38, s38, 3
s_mul_i32 s39, s38, 32768
s_add_u32 s36, s39, s59
s_lshl_b32 s38, s38, 12
s_add_u32 s38, s38, s19
s_add_u32 m0, s38, 0
s_nop 0
buffer_load_dwordx4 v148, s[32:35], s36 offen lds
ds_read_b128 a[12:15], v49 offset:0
ds_read_b128 a[16:19], v46 offset:4096
ds_read_b128 a[20:23], v47 offset:4096
s_add_u32 m0, m0, 1024
s_add_u32 s36, s36, 8192
buffer_load_dwordx4 v149, s[32:35], s36 offen lds
ds_read_b128 a[24:27], v48 offset:4096
ds_read_b128 a[28:31], v49 offset:4096
ds_read_b128 a[32:35], v46 offset:8192
ds_read_b128 a[36:39], v47 offset:8192
s_add_u32 m0, m0, 1024
s_add_u32 s36, s36, 8192
buffer_load_dwordx4 v148, s[32:35], s36 offen lds
ds_read_b128 a[40:43], v48 offset:8192
ds_read_b128 a[44:47], v49 offset:8192
ds_read_b128 a[48:51], v46 offset:12288
s_add_u32 m0, m0, 1024
s_add_u32 s36, s36, 8192
buffer_load_dwordx4 v149, s[32:35], s36 offen lds
ds_read_b128 a[52:55], v47 offset:12288
ds_read_b128 a[56:59], v48 offset:12288
ds_read_b128 a[60:63], v49 offset:12288
s_mov_b32 s96, s12
s_and_b32 s97, s13, 0xffff
s_mov_b32 s98, 67108864
s_mov_b32 s99, 0x20000
s_lshl_b32 s37, s4, 24
s_lshl_b32 s38, s3, 21
s_add_u32 s37, s37, s38
s_lshl_b32 s38, s5, 16
s_add_u32 s37, s37, s38
s_add_u32 s37, s37, 1572864
s_add_u32 s37, s37, s19
s_lshl_b32 s38, s57, 3
s_add_u32 s66, s28, s38
s_addc_u32 s67, s29, 0
s_load_dwordx2 s[64:65], s[66:67], 0
s_waitcnt lgkmcnt(0)
s_add_u32 m0, s19, 65536
s_add_u32 s36, s37, 0
buffer_load_dwordx4 v146, s[96:99], s36 offen nt lds
s_add_u32 m0, s19, 66560
s_add_u32 s36, s37, 1024
buffer_load_dwordx4 v147, s[96:99], s36 offen nt lds
s_add_u32 m0, s19, 67584
s_add_u32 s36, s37, 2048
buffer_load_dwordx4 v146, s[96:99], s36 offen nt lds
s_add_u32 m0, s19, 68608
s_add_u32 s36, s37, 3072
buffer_load_dwordx4 v147, s[96:99], s36 offen nt lds
s_add_u32 m0, s19, 69632
s_add_u32 s36, s37, 4096
buffer_load_dwordx4 v146, s[96:99], s36 offen nt lds
s_add_u32 m0, s19, 70656
s_add_u32 s36, s37, 5120
buffer_load_dwordx4 v147, s[96:99], s36 offen nt lds
s_add_u32 m0, s19, 71680
s_add_u32 s36, s37, 6144
buffer_load_dwordx4 v146, s[96:99], s36 offen nt lds
s_add_u32 m0, s19, 72704
s_add_u32 s36, s37, 7168
buffer_load_dwordx4 v147, s[96:99], s36 offen nt lds
s_waitcnt lgkmcnt(0)
s_cmp_ge_u32 s64, 8
s_cbranch_scc1 Lfd_7
s_lshl_b32 s38, s57, 3
v_mov_b32 v42, s38
s_mov_b32 s56, 0
Lfl_6:
global_load_dwordx2 v[44:45], v42, s[28:29] sc1
s_waitcnt vmcnt(0)
v_readfirstlane_b32 s64, v44
v_readfirstlane_b32 s65, v45
s_nop 3
s_cmp_ge_u32 s64, 8
s_cbranch_scc1 Lfd_7
s_add_u32 s56, s56, 1
s_cmp_lt_u32 s56, 40000
s_cbranch_scc1 Lfl_6
Lfd_7:
s_and_b32 s38, s65, 0xffff
s_lshr_b32 s39, s65, 16
s_mul_i32 s38, s38, s38
s_lshl_b32 s39, s39, 3
s_cmp_eq_u32 s38, s39
s_cselect_b32 s7, 1, 0
s_cmp_eq_u32 s64, 8
s_cselect_b32 s7, s7, 0
s_waitcnt vmcnt(8)
s_add_u32 m0, s19, 73728
s_add_u32 s36, s37, 8192
buffer_load_dwordx4 v146, s[96:99], s36 offen nt lds
v_lshrrev_b32 v46, 4, v0
v_bfe_u32 v47, v0, 2, 2
v_lshl_add_u32 v48, v46, 3, v47
v_lshlrev_b32 v48, 7, v48
v_lshrrev_b32 v49, 1, v47
v_and_b32 v46, 1, v46
v_lshl_or_b32 v49, v46, 1, v49
v_lshlrev_b32 v49, 1, v49
v_bfe_u32 v46, v0, 1, 1
v_xor_b32 v49, v49, v46
v_lshl_add_u32 v48, v49, 4, v48
v_and_b32 v46, 1, v0
v_lshl_add_u32 v48, v46, 3, v48
s_add_u32 m0, s19, 74752
s_add_u32 s36, s37, 9216
buffer_load_dwordx4 v147, s[96:99], s36 offen nt lds
s_lshl_b32 s68, s6, 14
s_add_u32 s68, s68, 0
v_add_u32 v48, s68, v48
v_xor_b32 v42, 0, v48
v_xor_b32 v43, 32, v48
v_xor_b32 v44, 64, v48
v_xor_b32 v45, 96, v48
ds_read_b64_tr_b16 a[192:193], v42 offset:0
ds_read_b64_tr_b16 a[194:195], v42 offset:512
ds_read_b64_tr_b16 a[196:197], v42 offset:4096
ds_read_b64_tr_b16 a[198:199], v42 offset:4608
ds_read_b64_tr_b16 a[200:201], v42 offset:8192
ds_read_b64_tr_b16 a[202:203], v42 offset:8704
s_add_u32 m0, s19, 75776
s_add_u32 s36, s37, 10240
buffer_load_dwordx4 v146, s[96:99], s36 offen nt lds
ds_read_b64_tr_b16 a[204:205], v42 offset:12288
ds_read_b64_tr_b16 a[206:207], v42 offset:12800
ds_read_b64_tr_b16 a[208:209], v43 offset:0
ds_read_b64_tr_b16 a[210:211], v43 offset:512
ds_read_b64_tr_b16 a[212:213], v43 offset:4096
ds_read_b64_tr_b16 a[214:215], v43 offset:4608
ds_read_b64_tr_b16 a[216:217], v43 offset:8192
ds_read_b64_tr_b16 a[218:219], v43 offset:8704
ds_read_b64_tr_b16 a[220:221], v43 offset:12288
ds_read_b64_tr_b16 a[222:223], v43 offset:12800
ds_read_b64_tr_b16 a[224:225], v44 offset:0
ds_read_b64_tr_b16 a[226:227], v44 offset:512
ds_read_b64_tr_b16 a[228:229], v44 offset:4096
s_add_u32 m0, s19, 76800
s_add_u32 s36, s37, 11264
buffer_load_dwordx4 v147, s[96:99], s36 offen nt lds
ds_read_b64_tr_b16 a[230:231], v44 offset:4608
ds_read_b64_tr_b16 a[232:233], v44 offset:8192
ds_read_b64_tr_b16 a[234:235], v44 offset:8704
ds_read_b64_tr_b16 a[236:237], v44 offset:12288
ds_read_b64_tr_b16 a[238:239], v44 offset:12800
ds_read_b64_tr_b16 a[240:241], v45 offset:0
ds_read_b64_tr_b16 a[242:243], v45 offset:512
ds_read_b64_tr_b16 a[244:245], v45 offset:4096
ds_read_b64_tr_b16 a[246:247], v45 offset:4608
ds_read_b64_tr_b16 a[248:249], v45 offset:8192
ds_read_b64_tr_b16 a[250:251], v45 offset:8704
ds_read_b64_tr_b16 a[252:253], v45 offset:12288
ds_read_b64_tr_b16 a[254:255], v45 offset:12800
v_lshrrev_b32 v42, 3, v0
v_and_b32 v43, 7, v0
v_bfe_u32 v44, v0, 4, 1
v_lshlrev_b32 v44, 1, v44
v_xor_b32 v43, v43, v44
v_cmp_gt_u32 vcc, 4, v43
v_and_b32 v43, 3, v43
v_lshlrev_b32 v43, 4, v43
v_mul_u32_u24 v42, 3584, v42
v_add_u32 v42, v42, v43
s_cmp_lg_u32 s77, 7
s_cbranch_scc1 Lg7o_8
v_mov_b32 v42, 0
Lg7o_8:
s_min_u32 s69, s77, 6
s_mul_i32 s70, s3, 7
s_add_u32 s69, s69, s70
s_and_b32 s70, s69, 1
s_lshl_b32 s76, s4, 1
s_add_u32 s76, s76, s70
s_mul_i32 s70, s76, 57344
v_add_u32 v42, s70, v42
s_lshl_b32 s69, s69, 6
s_mul_i32 s70, s6, 458752
s_add_u32 s69, s69, s70
v_add_u32 v42, s69, v42
v_mov_b32 v44, s22
v_mov_b32 v45, s23
v_mov_b32 v46, s20
v_mov_b32 v47, s21
v_cndmask_b32 v150, v44, v46, vcc
v_cndmask_b32 v151, v45, v47, vcc
v_cndmask_b32 v152, v46, v44, vcc
v_cndmask_b32 v153, v47, v45, vcc
v_add_co_u32 v150, vcc, v150, v42
s_nop 1
v_addc_co_u32 v151, vcc, 0, v151, vcc
v_add_u32 v42, 28672, v42
v_add_co_u32 v152, vcc, v152, v42
s_nop 1
v_addc_co_u32 v153, vcc, 0, v153, vcc
s_add_u32 s48, s30, 1048576
s_addc_u32 s49, s31, 0
s_mov_b64 exec, s[44:45]
global_load_dwordx4 v[64:67], v5, s[48:49] offset:0 sc1
global_load_dwordx4 v[68:71], v5, s[48:49] offset:256 sc1
global_load_dwordx4 v[72:75], v5, s[48:49] offset:512 sc1
global_load_dwordx4 v[76:79], v5, s[48:49] offset:768 sc1
s_mov_b64 exec, -1
s_add_u32 m0, s19, 77824
s_add_u32 s36, s37, 12288
buffer_load_dwordx4 v146, s[96:99], s36 offen nt lds
s_add_u32 m0, s19, 78848
s_add_u32 s36, s37, 13312
buffer_load_dwordx4 v147, s[96:99], s36 offen nt lds
s_add_u32 m0, s19, 79872
s_add_u32 s36, s37, 14336
buffer_load_dwordx4 v146, s[96:99], s36 offen nt lds
s_add_u32 m0, s19, 80896
s_add_u32 s36, s37, 15360
buffer_load_dwordx4 v147, s[96:99], s36 offen nt lds
v_lshlrev_b32 v154, 2, v0
global_load_dword v155, v154, s[28:29] sc1
s_waitcnt lgkmcnt(0)
s_waitcnt vmcnt(5)
s_mov_b64 exec, s[44:45]
v_max3_u32 v42, v64, v65, v66
v_max3_u32 v42, v42, v67, v68
v_max3_u32 v42, v42, v69, v70
v_max3_u32 v42, v42, v71, v72
v_max3_u32 v42, v42, v73, v74
v_max3_u32 v42, v42, v75, v76
v_max3_u32 v42, v42, v77, v78
v_max_u32 v42, v42, v79
v_cmp_eq_u32 vcc, -1, v42
s_mov_b64 exec, -1
s_cbranch_vccz Lq1_9
s_mov_b64 exec, s[44:45]
s_mov_b32 s56, 0
Lpoll_10:
global_load_dwordx4 v[64:67], v5, s[48:49] offset:0 sc1
global_load_dwordx4 v[68:71], v5, s[48:49] offset:256 sc1
global_load_dwordx4 v[72:75], v5, s[48:49] offset:512 sc1
global_load_dwordx4 v[76:79], v5, s[48:49] offset:768 sc1
s_add_u32 s56, s56, 1
s_cmp_ge_u32 s56, 40000
s_cbranch_scc1 Lgot_11
s_waitcnt vmcnt(0)
v_max3_u32 v42, v64, v65, v66
v_max3_u32 v42, v42, v67, v68
v_max3_u32 v42, v42, v69, v70
v_max3_u32 v42, v42, v71, v72
v_max3_u32 v42, v42, v73, v74
v_max3_u32 v42, v42, v75, v76
v_max3_u32 v42, v42, v77, v78
v_max_u32 v42, v42, v79
v_cmp_eq_u32 vcc, -1, v42
s_cbranch_vccnz Lpoll_10
Lgot_11:
s_waitcnt vmcnt(0)
s_mov_b64 exec, -1
Lq1_9:
s_waitcnt lgkmcnt(0)
s_add_u32 s38, s76, 0
s_and_b32 s38, s38, 7
s_mov_b32 s39, 57344
s_cmp_eq_u32 s38, 7
s_cselect_b32 s39, 4294565888, s39
s_cselect_b32 s36, -1, 0
v_mov_b32 v156, s36
s_lshl_b32 s38, s38, 11
s_add_u32 s38, s38, s19
s_add_u32 m0, s38, 0
s_nop 0
global_load_lds_dwordx4 v[150:151], off
v_add_co_u32 v150, vcc, s39, v150
s_nop 1
v_addc_co_u32 v151, vcc, v156, v151, vcc
v_mfma_f32_16x16x32_bf16 v[80:83], a[0:3], v[64:67], 0
v_lshrrev_b32 v46, 4, v0
v_bfe_u32 v47, v0, 2, 2
v_lshl_add_u32 v46, v46, 2, v47
v_mfma_f32_16x16x32_bf16 v[80:83], a[4:7], v[68:71], v[80:83]
v_and_b32 v47, 7, v46
v_lshlrev_b32 v47, 1, v47
v_bfe_u32 v48, v0, 1, 1
v_mfma_f32_16x16x32_bf16 v[80:83], a[8:11], v[72:75], v[80:83]
v_xor_b32 v47, v47, v48
v_lshlrev_b32 v47, 4, v47
v_lshl_add_u32 v46, v46, 8, v47
v_mfma_f32_16x16x32_bf16 v[80:83], a[12:15], v[76:79], v[80:83]
v_and_b32 v47, 1, v0
v_lshl_add_u32 v46, v47, 3, v46
s_add_u32 s68, s19, 65536
v_mfma_f32_16x16x32_bf16 v[84:87], a[16:19], v[64:67], 0
v_add_u32 v46, s68, v46
v_xor_b32 v47, 0, v46
v_xor_b32 v48, 32, v46
v_mfma_f32_16x16x32_bf16 v[84:87], a[20:23], v[68:71], v[84:87]
s_add_u32 m0, s38, 1024
s_nop 0
global_load_lds_dwordx4 v[152:153], off
v_add_co_u32 v152, vcc, s39, v152
s_nop 1
v_addc_co_u32 v153, vcc, v156, v153, vcc
v_max3_f32 v42, v80, v81, v82
v_xor_b32 v49, 64, v46
v_xor_b32 v50, 96, v46
v_mfma_f32_16x16x32_bf16 v[84:87], a[24:27], v[72:75], v[84:87]
v_xor_b32 v51, 128, v46
v_xor_b32 v52, 160, v46
v_xor_b32 v53, 192, v46
v_mfma_f32_16x16x32_bf16 v[84:87], a[28:31], v[76:79], v[84:87]
v_xor_b32 v54, 224, v46
v_mfma_f32_16x16x32_bf16 v[88:91], a[32:35], v[64:67], 0
v_mfma_f32_16x16x32_bf16 v[88:91], a[36:39], v[68:71], v[88:91]
v_mfma_f32_16x16x32_bf16 v[88:91], a[40:43], v[72:75], v[88:91]
v_mfma_f32_16x16x32_bf16 v[88:91], a[44:47], v[76:79], v[88:91]
v_mfma_f32_16x16x32_bf16 v[92:95], a[48:51], v[64:67], 0
s_nop 1
v_max3_f32 v42, v42, v83, v84
v_mfma_f32_16x16x32_bf16 v[92:95], a[52:55], v[68:71], v[92:95]
v_max3_f32 v42, v42, v85, v86
v_mfma_f32_16x16x32_bf16 v[92:95], a[56:59], v[72:75], v[92:95]
s_nop 0
v_max3_f32 v42, v42, v87, v88
v_max3_f32 v42, v42, v89, v90
v_mfma_f32_16x16x32_bf16 v[92:95], a[60:63], v[76:79], v[92:95]
s_add_u32 s38, s76, 1
s_and_b32 s38, s38, 7
s_mov_b32 s39, 57344
s_cmp_eq_u32 s38, 7
s_cselect_b32 s39, 4294565888, s39
s_cselect_b32 s36, -1, 0
v_mov_b32 v156, s36
s_lshl_b32 s38, s38, 11
s_add_u32 s38, s38, s19
s_add_u32 m0, s38, 0
s_nop 0
global_load_lds_dwordx4 v[150:151], off
v_add_co_u32 v150, vcc, s39, v150
s_nop 1
v_addc_co_u32 v151, vcc, v156, v151, vcc
v_max3_f32 v42, v42, v91, v92
v_max3_f32 v42, v42, v93, v94
v_max_f32 v42, v42, v95
v_mov_b32 v43, v42
s_nop 1
v_permlane32_swap_b32 v42, v43
v_max_f32 v42, v42, v43
v_mov_b32 v43, v42
s_nop 1
v_permlane16_swap_b32 v42, v43
v_max_f32 v42, v42, v43
v_mul_f32 v62, s18, v42
v_pk_fma_f32 v[80:81], v[80:81], s[78:79], v[62:63] op_sel_hi:[1,1,0] neg_lo:[0,0,1] neg_hi:[0,0,1]
v_pk_fma_f32 v[82:83], v[82:83], s[78:79], v[62:63] op_sel_hi:[1,1,0] neg_lo:[0,0,1] neg_hi:[0,0,1]
v_pk_fma_f32 v[84:85], v[84:85], s[78:79], v[62:63] op_sel_hi:[1,1,0] neg_lo:[0,0,1] neg_hi:[0,0,1]
v_pk_fma_f32 v[86:87], v[86:87], s[78:79], v[62:63] op_sel_hi:[1,1,0] neg_lo:[0,0,1] neg_hi:[0,0,1]
v_pk_fma_f32 v[88:89], v[88:89], s[78:79], v[62:63] op_sel_hi:[1,1,0] neg_lo:[0,0,1] neg_hi:[0,0,1]
v_pk_fma_f32 v[90:91], v[90:91], s[78:79], v[62:63] op_sel_hi:[1,1,0] neg_lo:[0,0,1] neg_hi:[0,0,1]
v_pk_fma_f32 v[92:93], v[92:93], s[78:79], v[62:63] op_sel_hi:[1,1,0] neg_lo:[0,0,1] neg_hi:[0,0,1]
v_pk_fma_f32 v[94:95], v[94:95], s[78:79], v[62:63] op_sel_hi:[1,1,0] neg_lo:[0,0,1] neg_hi:[0,0,1]
v_exp_f32 v80, v80
v_exp_f32 v81, v81
v_exp_f32 v82, v82
s_add_u32 m0, s38, 1024
s_nop 0
global_load_lds_dwordx4 v[152:153], off
v_add_co_u32 v152, vcc, s39, v152
s_nop 1
v_addc_co_u32 v153, vcc, v156, v153, vcc
v_exp_f32 v83, v83
v_exp_f32 v84, v84
v_exp_f32 v85, v85
v_exp_f32 v86, v86
v_exp_f32 v87, v87
v_exp_f32 v88, v88
v_exp_f32 v89, v89
v_exp_f32 v90, v90
v_exp_f32 v91, v91
v_exp_f32 v92, v92
v_exp_f32 v93, v93
v_exp_f32 v94, v94
v_exp_f32 v95, v95
v_cvt_pk_bf16_f32 v96, v80, v81
v_cvt_pk_bf16_f32 v97, v82, v83
v_cvt_pk_bf16_f32 v98, v84, v85
v_cvt_pk_bf16_f32 v99, v86, v87
v_cvt_pk_bf16_f32 v100, v88, v89
v_cvt_pk_bf16_f32 v101, v90, v91
v_cvt_pk_bf16_f32 v102, v92, v93
v_cvt_pk_bf16_f32 v103, v94, v95
s_waitcnt vmcnt(17)
s_add_u32 s38, s76, 2
s_and_b32 s38, s38, 7
s_mov_b32 s39, 57344
s_cmp_eq_u32 s38, 7
s_cselect_b32 s39, 4294565888, s39
s_cselect_b32 s36, -1, 0
v_mov_b32 v156, s36
s_lshl_b32 s38, s38, 11
s_add_u32 s38, s38, s19
s_add_u32 m0, s38, 0
s_nop 0
global_load_lds_dwordx4 v[150:151], off
v_add_co_u32 v150, vcc, s39, v150
s_nop 1
v_addc_co_u32 v151, vcc, v156, v151, vcc
ds_read_b64_tr_b16 a[64:65], v47 offset:0
ds_read_b64_tr_b16 a[66:67], v47 offset:4096
ds_read_b64_tr_b16 a[68:69], v48 offset:0
ds_read_b64_tr_b16 a[70:71], v48 offset:4096
ds_read_b64_tr_b16 a[72:73], v49 offset:0
ds_read_b64_tr_b16 a[74:75], v49 offset:4096
ds_read_b64_tr_b16 a[76:77], v50 offset:0
ds_read_b64_tr_b16 a[78:79], v50 offset:4096
s_add_u32 m0, s38, 1024
s_nop 0
global_load_lds_dwordx4 v[152:153], off
v_add_co_u32 v152, vcc, s39, v152
s_nop 1
v_addc_co_u32 v153, vcc, v156, v153, vcc
ds_read_b64_tr_b16 a[80:81], v51 offset:0
ds_read_b64_tr_b16 a[82:83], v51 offset:4096
ds_read_b64_tr_b16 a[84:85], v52 offset:0
ds_read_b64_tr_b16 a[86:87], v52 offset:4096
ds_read_b64_tr_b16 a[88:89], v53 offset:0
ds_read_b64_tr_b16 a[90:91], v53 offset:4096
ds_read_b64_tr_b16 a[92:93], v54 offset:0
ds_read_b64_tr_b16 a[94:95], v54 offset:4096
s_waitcnt lgkmcnt(0)
s_add_u32 s38, s76, 3
s_and_b32 s38, s38, 7
s_mov_b32 s39, 57344
s_cmp_eq_u32 s38, 7
s_cselect_b32 s39, 4294565888, s39
s_cselect_b32 s36, -1, 0
v_mov_b32 v156, s36
s_lshl_b32 s38, s38, 11
s_add_u32 s38, s38, s19
s_add_u32 m0, s38, 0
s_nop 0
global_load_lds_dwordx4 v[150:151], off
v_add_co_u32 v150, vcc, s39, v150
s_nop 1
v_addc_co_u32 v151, vcc, v156, v151, vcc
v_mfma_f32_16x16x32_bf16 v[136:139], v[20:23], v[96:99], 0
v_mfma_f32_16x16x32_bf16 v[104:107], a[64:67], v[96:99], 0
v_mfma_f32_16x16x32_bf16 v[108:111], a[68:71], v[96:99], 0
v_mfma_f32_16x16x32_bf16 v[112:115], a[72:75], v[96:99], 0
v_mfma_f32_16x16x32_bf16 v[116:119], a[76:79], v[96:99], 0
s_add_u32 m0, s38, 1024
s_nop 0
global_load_lds_dwordx4 v[152:153], off
v_add_co_u32 v152, vcc, s39, v152
s_nop 1
v_addc_co_u32 v153, vcc, v156, v153, vcc
v_mfma_f32_16x16x32_bf16 v[120:123], a[80:83], v[96:99], 0
v_mfma_f32_16x16x32_bf16 v[124:127], a[84:87], v[96:99], 0
v_mfma_f32_16x16x32_bf16 v[128:131], a[88:91], v[96:99], 0
v_mfma_f32_16x16x32_bf16 v[132:135], a[92:95], v[96:99], 0
s_waitcnt vmcnt(9)
ds_read_b64_tr_b16 a[96:97], v47 offset:8192
ds_read_b64_tr_b16 a[98:99], v47 offset:12288
ds_read_b64_tr_b16 a[100:101], v48 offset:8192
ds_read_b64_tr_b16 a[102:103], v48 offset:12288
ds_read_b64_tr_b16 a[104:105], v49 offset:8192
ds_read_b64_tr_b16 a[106:107], v49 offset:12288
ds_read_b64_tr_b16 a[108:109], v50 offset:8192
ds_read_b64_tr_b16 a[110:111], v50 offset:12288
ds_read_b64_tr_b16 a[112:113], v51 offset:8192
ds_read_b64_tr_b16 a[114:115], v51 offset:12288
ds_read_b64_tr_b16 a[116:117], v52 offset:8192
ds_read_b64_tr_b16 a[118:119], v52 offset:12288
ds_read_b64_tr_b16 a[120:121], v53 offset:8192
ds_read_b64_tr_b16 a[122:123], v53 offset:12288
ds_read_b64_tr_b16 a[124:125], v54 offset:8192
ds_read_b64_tr_b16 a[126:127], v54 offset:12288
s_waitcnt vmcnt(8)
s_mov_b32 s56, 0
Laf_12:
v_cmp_gt_u32 vcc, 8, v155
s_and_b64 vcc, vcc, s[50:51]
s_cbranch_vccz Lad_13
global_load_dword v155, v154, s[28:29] sc1
s_add_u32 s56, s56, 1
s_cmp_ge_u32 s56, 40000
s_cbranch_scc1 Lad_13
s_waitcnt vmcnt(0)
s_branch Laf_12
Lad_13:
s_waitcnt lgkmcnt(0)
s_add_u32 s38, s76, 4
s_and_b32 s38, s38, 7
s_mov_b32 s39, 57344
s_cmp_eq_u32 s38, 7
s_cselect_b32 s39, 4294565888, s39
s_cselect_b32 s36, -1, 0
v_mov_b32 v156, s36
s_lshl_b32 s38, s38, 11
s_add_u32 s38, s38, s19
s_add_u32 m0, s38, 0
s_nop 0
global_load_lds_dwordx4 v[150:151], off
v_add_co_u32 v150, vcc, s39, v150
s_nop 1
v_addc_co_u32 v151, vcc, v156, v151, vcc
v_mfma_f32_16x16x32_bf16 v[136:139], v[20:23], v[100:103], v[136:139]
v_mfma_f32_16x16x32_bf16 v[104:107], a[96:99], v[100:103], v[104:107]
v_mfma_f32_16x16x32_bf16 v[108:111], a[100:103], v[100:103], v[108:111]
v_mfma_f32_16x16x32_bf16 v[112:115], a[104:107], v[100:103], v[112:115]
v_mfma_f32_16x16x32_bf16 v[116:119], a[108:111], v[100:103], v[116:119]
s_add_u32 m0, s38, 1024
s_nop 0
global_load_lds_dwordx4 v[152:153], off
v_add_co_u32 v152, vcc, s39, v152
s_nop 1
v_addc_co_u32 v153, vcc, v156, v153, vcc
v_mfma_f32_16x16x32_bf16 v[120:123], a[112:115], v[100:103], v[120:123]
v_mfma_f32_16x16x32_bf16 v[124:127], a[116:119], v[100:103], v[124:127]
v_mov_b32 v63, v136
v_mfma_f32_16x16x32_bf16 v[128:131], a[120:123], v[100:103], v[128:131]
v_mfma_f32_16x16x32_bf16 v[132:135], a[124:127], v[100:103], v[132:135]
s_mov_b64 exec, s[44:45]
ds_write_b128 v18, v[104:107] offset:0
ds_write_b128 v18, v[108:111] offset:64
ds_write_b128 v18, v[112:115] offset:128
ds_write_b128 v18, v[116:119] offset:192
ds_write_b128 v18, v[120:123] offset:256
ds_write_b128 v18, v[124:127] offset:320
ds_write_b128 v18, v[128:131] offset:384
ds_write_b128 v18, v[132:135] offset:448
s_mov_b64 exec, s[62:63]
ds_write_b64 v25, v[62:63]
s_mov_b64 exec, -1
s_add_u32 s38, s76, 5
s_and_b32 s38, s38, 7
s_mov_b32 s39, 57344
s_cmp_eq_u32 s38, 7
s_cselect_b32 s39, 4294565888, s39
s_cselect_b32 s36, -1, 0
v_mov_b32 v156, s36
s_lshl_b32 s38, s38, 11
s_add_u32 s38, s38, s19
s_add_u32 m0, s38, 0
s_nop 0
global_load_lds_dwordx4 v[150:151], off
v_add_co_u32 v150, vcc, s39, v150
s_nop 1
v_addc_co_u32 v151, vcc, v156, v151, vcc
s_add_u32 m0, s38, 1024
s_nop 0
global_load_lds_dwordx4 v[152:153], off
v_add_co_u32 v152, vcc, s39, v152
s_nop 1
v_addc_co_u32 v153, vcc, v156, v153, vcc
s_add_u32 s38, s76, 6
s_and_b32 s38, s38, 7
s_mov_b32 s39, 57344
s_cmp_eq_u32 s38, 7
s_cselect_b32 s39, 4294565888, s39
s_cselect_b32 s36, -1, 0
v_mov_b32 v156, s36
s_lshl_b32 s38, s38, 11
s_add_u32 s38, s38, s19
s_add_u32 m0, s38, 0
s_nop 0
global_load_lds_dwordx4 v[150:151], off
v_add_co_u32 v150, vcc, s39, v150
s_nop 1
v_addc_co_u32 v151, vcc, v156, v151, vcc
s_add_u32 m0, s38, 1024
s_nop 0
global_load_lds_dwordx4 v[152:153], off
v_add_co_u32 v152, vcc, s39, v152
s_nop 1
v_addc_co_u32 v153, vcc, v156, v153, vcc
s_add_u32 s38, s76, 7
s_and_b32 s38, s38, 7
s_mov_b32 s39, 57344
s_cmp_eq_u32 s38, 7
s_cselect_b32 s39, 4294565888, s39
s_cselect_b32 s36, -1, 0
v_mov_b32 v156, s36
s_lshl_b32 s38, s38, 11
s_add_u32 s38, s38, s19
s_add_u32 m0, s38, 0
s_nop 0
global_load_lds_dwordx4 v[150:151], off
v_add_co_u32 v150, vcc, s39, v150
s_nop 1
v_addc_co_u32 v151, vcc, v156, v151, vcc
s_add_u32 m0, s38, 1024
s_nop 0
global_load_lds_dwordx4 v[152:153], off
v_add_co_u32 v152, vcc, s39, v152
s_nop 1
v_addc_co_u32 v153, vcc, v156, v153, vcc
s_waitcnt lgkmcnt(0)
s_barrier
ds_read_b128 v[46:49], v26
ds_read_b128 v[50:53], v26 offset:16
ds_read_b64 v[54:55], v19 offset:0
ds_read_b64 v[56:57], v19 offset:2112
ds_read_b64 v[58:59], v19 offset:4224
ds_read_b64 v[60:61], v19 offset:6336
s_add_u32 s48, s46, 32768
s_addc_u32 s49, s47, 0
s_waitcnt lgkmcnt(4)
v_max3_f32 v42, v46, v48, v50
v_max_f32 v42, v42, v52
v_sub_f32 v46, v46, v42
v_sub_f32 v48, v48, v42
v_exp_f32 v46, v46
v_sub_f32 v50, v50, v42
v_exp_f32 v48, v48
s_waitcnt lgkmcnt(0)
v_sub_f32 v52, v52, v42
v_exp_f32 v50, v50
v_mul_f32 v44, v46, v54
v_mul_f32 v45, v46, v55
v_exp_f32 v52, v52
v_mul_f32 v43, v46, v47
v_fmac_f32 v44, v48, v56
v_fmac_f32 v45, v48, v57
v_fmac_f32 v43, v48, v49
v_fmac_f32 v44, v50, v58
v_fmac_f32 v45, v50, v59
v_fmac_f32 v43, v50, v51
v_fmac_f32 v44, v52, v60
v_fmac_f32 v45, v52, v61
v_fmac_f32 v43, v52, v53
v_cvt_pk_bf16_f32 v44, v44, v45
s_cmp_eq_u32 s7, 0
s_cbranch_scc1 Lsl_14
global_store_dword v7, v44, s[48:49]
s_branch Lse_15
Lsl_14:
global_store_dword v7, v44, s[48:49] sc1
Lse_15:
s_add_u32 s48, s46, 294912
s_addc_u32 s49, s47, 0
s_mov_b64 exec, 1
s_cmp_eq_u32 s7, 0
s_cbranch_scc1 Lsl_16
global_store_dwordx2 v8, v[42:43], s[48:49]
s_branch Lse_17
Lsl_16:
global_store_dwordx2 v8, v[42:43], s[48:49] sc1
Lse_17:
s_mov_b64 exec, -1
s_cmp_eq_u32 s7, 0
s_cbranch_scc1 Lpt_18
s_add_u32 s48, s46, 557056
s_addc_u32 s49, s47, 0
global_load_dwordx4 v[172:175], v2, s[48:49] sc1
global_load_dwordx4 v[172:175], v2, s[48:49] offset:128 sc1
s_add_u32 s48, s46, 819200
s_addc_u32 s49, s47, 0
global_load_dwordx2 v[172:173], v3, s[48:49] sc1
s_add_u32 s48, s46, 524288
s_addc_u32 s49, s47, 0
v_lshlrev_b32 v176, 4, v0
s_lshl_b32 s38, s57, 10
v_add_u32 v176, s38, v176
global_load_dwordx4 v[172:175], v176, s[48:49] sc1
s_add_u32 s48, s46, 425984
s_addc_u32 s49, s47, 0
s_mov_b64 exec, s[42:43]
global_load_dwordx4 v[172:175], v4, s[48:49] sc1
s_mov_b64 exec, -1
s_add_u32 s48, s46, 950272
s_addc_u32 s49, s47, 0
s_mov_b64 exec, s[42:43]
global_load_dwordx4 v[172:175], v4, s[48:49] sc1
s_mov_b64 exec, -1
Lpt_18:
s_add_u32 s48, s46, 32768
s_addc_u32 s49, s47, 0
s_add_u32 s8, s46, 294912
s_addc_u32 s9, s47, 0
s_mov_b32 s56, 0
Lpoll_19:
global_load_dwordx4 v[32:35], v2, s[48:49] sc1
global_load_dwordx4 v[36:39], v2, s[48:49] offset:128 sc1
global_load_dwordx2 v[40:41], v3, s[8:9] sc1
s_add_u32 s56, s56, 1
s_cmp_ge_u32 s56, 40000
s_cbranch_scc1 Lgot_20
s_waitcnt vmcnt(0)
v_mfma_f32_16x16x32_bf16 v[64:67], v[32:35], a[192:195], 0
v_max3_u32 v42, v32, v33, v34
v_max3_u32 v42, v42, v35, v36
v_max3_u32 v42, v42, v37, v38
v_mfma_f32_16x16x32_bf16 v[68:71], v[32:35], a[196:199], 0
v_max3_u32 v42, v42, v39, v40
v_max_u32 v42, v42, v41
v_cmp_eq_u32 vcc, -1, v42
v_mfma_f32_16x16x32_bf16 v[64:67], v[36:39], a[200:203], v[64:67]
v_mfma_f32_16x16x32_bf16 v[68:71], v[36:39], a[204:207], v[68:71]
s_cbranch_vccnz Lpoll_19
Lgot_20:
v_mfma_f32_16x16x32_bf16 v[72:75], v[32:35], a[208:211], 0
v_max_f32_dpp v58, v40, v40 row_ror:4 row_mask:0xf bank_mask:0xf
s_nop 4
v_add_f32 v64, v64, v69
v_add_f32 v66, v66, v71
v_mfma_f32_16x16x32_bf16 v[76:79], v[32:35], a[212:215], 0
v_max_f32_dpp v58, v58, v58 row_ror:2 row_mask:0xf bank_mask:0xf
v_mfma_f32_16x16x32_bf16 v[72:75], v[36:39], a[216:219], v[72:75]
s_nop 0
v_max_f32_dpp v58, v58, v58 row_ror:1 row_mask:0xf bank_mask:0xf
v_sub_f32 v59, v40, v58
v_mfma_f32_16x16x32_bf16 v[76:79], v[36:39], a[220:223], v[76:79]
v_exp_f32 v59, v59
v_mfma_f32_16x16x32_bf16 v[80:83], v[32:35], a[224:227], 0
v_mul_f32 v60, v59, v41
v_mfma_f32_16x16x32_bf16 v[84:87], v[32:35], a[228:231], 0
s_nop 0
v_add_f32_dpp v60, v60, v60 row_ror:4 row_mask:0xf bank_mask:0xf
v_mfma_f32_16x16x32_bf16 v[80:83], v[36:39], a[232:235], v[80:83]
s_nop 0
v_add_f32_dpp v60, v60, v60 row_ror:2 row_mask:0xf bank_mask:0xf
v_add_f32 v72, v72, v77
v_mfma_f32_16x16x32_bf16 v[84:87], v[36:39], a[236:239], v[84:87]
v_add_f32_dpp v60, v60, v60 row_ror:1 row_mask:0xf bank_mask:0xf
v_rcp_f32 v60, v60
v_mfma_f32_16x16x32_bf16 v[88:91], v[32:35], a[240:243], 0
v_mul_f32 v59, v59, v60
v_add_f32 v74, v74, v79
v_mfma_f32_16x16x32_bf16 v[92:95], v[32:35], a[244:247], 0
v_mov_b32_dpp v61, v59 row_newbcast:0 row_mask:0xf bank_mask:0xf
v_mov_b32_dpp v62, v59 row_newbcast:1 row_mask:0xf bank_mask:0xf
v_add_f32 v80, v80, v85
v_mfma_f32_16x16x32_bf16 v[88:91], v[36:39], a[248:251], v[88:91]
v_mul_f32 v54, v61, v64
v_mul_f32 v55, v61, v72
v_add_f32 v82, v82, v87
v_mfma_f32_16x16x32_bf16 v[92:95], v[36:39], a[252:255], v[92:95]
v_mul_f32 v56, v61, v80
v_fmac_f32 v54, v62, v66
v_fmac_f32 v55, v62, v74
v_fmac_f32 v56, v62, v82
s_nop 1
v_permlane32_swap_b32 v54, v56
v_add_f32 v54, v54, v56
v_add_f32 v88, v88, v93
v_add_f32 v90, v90, v95
v_mul_f32 v57, v61, v88
v_fmac_f32 v57, v62, v90
s_nop 1
v_permlane32_swap_b32 v55, v57
v_add_f32 v55, v55, v57
s_nop 1
v_permlane16_swap_b32 v54, v55
v_add_f32 v54, v54, v55
ds_write_b32 v13, v54 offset:2048
s_waitcnt lgkmcnt(0)
s_barrier
s_cmp_eq_u32 s6, 3
s_cbranch_scc1 Lg3_21
s_mov_b32 s32, s24
s_and_b32 s33, s25, 0xffff
s_mov_b32 s34, 1835008
s_mov_b32 s35, 0x20000
s_mul_i32 s59, s3, 224
s_mul_i32 s38, s6, 56
s_add_u32 s59, s59, s38
s_lshl_b32 s59, s59, 10
s_lshl_b32 s38, s5, 7
s_add_u32 s59, s59, s38
s_add_u32 m0, s19, 65536
s_add_u32 s36, s59, 0
buffer_load_dwordx4 v148, s[32:35], s36 offen lds
s_add_u32 m0, s19, 66560
s_add_u32 s36, s59, 8192
buffer_load_dwordx4 v149, s[32:35], s36 offen lds
s_add_u32 m0, s19, 67584
s_add_u32 s36, s59, 16384
buffer_load_dwordx4 v148, s[32:35], s36 offen lds
s_add_u32 m0, s19, 68608
s_add_u32 s36, s59, 24576
buffer_load_dwordx4 v149, s[32:35], s36 offen lds
s_add_u32 m0, s19, 69632
s_add_u32 s36, s59, 32768
buffer_load_dwordx4 v148, s[32:35], s36 offen lds
s_add_u32 m0, s19, 70656
s_add_u32 s36, s59, 40960
buffer_load_dwordx4 v149, s[32:35], s36 offen lds
s_add_u32 m0, s19, 71680
s_add_u32 s36, s59, 49152
buffer_load_dwordx4 v148, s[32:35], s36 offen lds
s_add_u32 m0, s19, 72704
s_add_u32 s36, s59, 57344
buffer_load_dwordx4 v149, s[32:35], s36 offen lds
v_lshrrev_b32 v46, 4, v0
v_bfe_u32 v47, v0, 2, 2
v_lshl_add_u32 v48, v46, 3, v47
v_lshlrev_b32 v48, 7, v48
v_lshrrev_b32 v49, 1, v47
v_and_b32 v46, 1, v46
v_lshl_or_b32 v49, v46, 1, v49
v_lshlrev_b32 v49, 1, v49
v_bfe_u32 v46, v0, 1, 1
v_xor_b32 v49, v49, v46
v_lshl_add_u32 v48, v49, 4, v48
v_and_b32 v46, 1, v0
v_lshl_add_u32 v48, v46, 3, v48
s_lshl_b32 s68, s6, 14
s_add_u32 s68, s68, 0
v_add_u32 v48, s68, v48
v_xor_b32 v42, 0, v48
v_xor_b32 v43, 32, v48
v_xor_b32 v44, 64, v48
v_xor_b32 v45, 96, v48
ds_read_b64_tr_b16 v[192:193], v42 offset:0
ds_read_b64_tr_b16 v[194:195], v42 offset:512
ds_read_b64_tr_b16 v[196:197], v42 offset:4096
ds_read_b64_tr_b16 v[198:199], v42 offset:4608
ds_read_b64_tr_b16 v[200:201], v42 offset:8192
ds_read_b64_tr_b16 v[202:203], v42 offset:8704
ds_read_b64_tr_b16 v[204:205], v42 offset:12288
ds_read_b64_tr_b16 v[206:207], v42 offset:12800
ds_read_b64_tr_b16 v[208:209], v43 offset:0
ds_read_b64_tr_b16 v[210:211], v43 offset:512
ds_read_b64_tr_b16 v[212:213], v43 offset:4096
ds_read_b64_tr_b16 v[214:215], v43 offset:4608
ds_read_b64_tr_b16 v[216:217], v43 offset:8192
ds_read_b64_tr_b16 v[218:219], v43 offset:8704
ds_read_b64_tr_b16 v[220:221], v43 offset:12288
ds_read_b64_tr_b16 v[222:223], v43 offset:12800
ds_read_b64_tr_b16 v[224:225], v44 offset:0
ds_read_b64_tr_b16 v[226:227], v44 offset:512
ds_read_b64_tr_b16 v[228:229], v44 offset:4096
ds_read_b64_tr_b16 v[230:231], v44 offset:4608
ds_read_b64_tr_b16 v[232:233], v44 offset:8192
ds_read_b64_tr_b16 v[234:235], v44 offset:8704
ds_read_b64_tr_b16 v[236:237], v44 offset:12288
ds_read_b64_tr_b16 v[238:239], v44 offset:12800
ds_read_b64_tr_b16 v[240:241], v45 offset:0
ds_read_b64_tr_b16 v[242:243], v45 offset:512
ds_read_b64_tr_b16 v[244:245], v45 offset:4096
ds_read_b64_tr_b16 v[246:247], v45 offset:4608
ds_read_b64_tr_b16 v[248:249], v45 offset:8192
ds_read_b64_tr_b16 v[250:251], v45 offset:8704
ds_read_b64_tr_b16 v[252:253], v45 offset:12288
ds_read_b64_tr_b16 v[254:255], v45 offset:12800
v_mov_b32 v136, 0
v_mov_b32 v137, 0
v_mov_b32 v138, 0
v_mov_b32 v139, 0
s_mov_b64 exec, s[40:41]
v_mov_b32 v136, 0x3f803f80
v_mov_b32 v137, 0x3f803f80
v_mov_b32 v138, 0x3f803f80
v_mov_b32 v139, 0x3f803f80
s_mov_b64 exec, -1
s_waitcnt lgkmcnt(0)
v_mfma_f32_16x16x32_bf16 v[64:67], v[136:139], v[192:195], 0
v_mfma_f32_16x16x32_bf16 v[68:71], v[136:139], v[196:199], 0
v_mfma_f32_16x16x32_bf16 v[64:67], v[136:139], v[200:203], v[64:67]
v_mfma_f32_16x16x32_bf16 v[68:71], v[136:139], v[204:207], v[68:71]
v_mfma_f32_16x16x32_bf16 v[72:75], v[136:139], v[208:211], 0
v_mfma_f32_16x16x32_bf16 v[76:79], v[136:139], v[212:215], 0
v_mfma_f32_16x16x32_bf16 v[72:75], v[136:139], v[216:219], v[72:75]
v_mfma_f32_16x16x32_bf16 v[76:79], v[136:139], v[220:223], v[76:79]
v_mfma_f32_16x16x32_bf16 v[80:83], v[136:139], v[224:227], 0
s_nop 1
v_add_f32 v54, v64, v66
v_mfma_f32_16x16x32_bf16 v[84:87], v[136:139], v[228:231], 0
v_add_f32 v69, v69, v71
v_add_f32 v54, v54, v69
v_add_f32 v55, v72, v74
v_mfma_f32_16x16x32_bf16 v[80:83], v[136:139], v[232:235], v[80:83]
v_add_f32 v77, v77, v79
v_add_f32 v55, v55, v77
v_mfma_f32_16x16x32_bf16 v[84:87], v[136:139], v[236:239], v[84:87]
v_mfma_f32_16x16x32_bf16 v[88:91], v[136:139], v[240:243], 0
v_mfma_f32_16x16x32_bf16 v[92:95], v[136:139], v[244:247], 0
v_mfma_f32_16x16x32_bf16 v[88:91], v[136:139], v[248:251], v[88:91]
s_nop 1
v_add_f32 v56, v80, v82
v_mfma_f32_16x16x32_bf16 v[92:95], v[136:139], v[252:255], v[92:95]
s_nop 0
v_add_f32 v85, v85, v87
v_add_f32 v56, v56, v85
s_nop 0
v_add_f32 v57, v88, v90
v_permlane32_swap_b32 v54, v56
v_add_f32 v54, v54, v56
s_nop 0
v_add_f32 v93, v93, v95
v_add_f32 v57, v57, v93
s_nop 1
v_permlane32_swap_b32 v55, v57
v_add_f32 v55, v55, v57
s_nop 1
v_permlane16_swap_b32 v54, v55
v_add_f32 v54, v54, v55
ds_write_b32 v13, v54 offset:4096
Lg3_21:
s_cmp_lg_u32 s6, 3
s_cbranch_scc1 Lw_22
ds_read2st64_b32 v[42:43], v14 offset0:8 offset1:9
ds_read2st64_b32 v[44:45], v14 offset0:10 offset1:11
s_add_u32 s48, s46, 303104
s_addc_u32 s49, s47, 0
s_waitcnt lgkmcnt(0)
v_add_f32 v42, v42, v43
v_add_f32 v44, v44, v45
v_add_f32 v54, v42, v44
v_add_f32 v54, v54, v17
s_nop 1
v_mov_b32_dpp v43, v54 quad_perm:[1,1,3,3] row_mask:0xf bank_mask:0xf
v_cvt_pk_bf16_f32 v55, v54, v43
s_mov_b64 exec, s[50:51]
global_store_dword v9, v55, s[48:49] sc1
s_mov_b64 exec, -1
v_mov_b32 v17, 0
s_mov_b32 s32, s24
s_and_b32 s33, s25, 0xffff
s_mov_b32 s34, 1835008
s_mov_b32 s35, 0x20000
s_mul_i32 s59, s3, 224
s_mul_i32 s38, s6, 56
s_add_u32 s59, s59, s38
s_lshl_b32 s59, s59, 10
s_lshl_b32 s38, s5, 7
s_add_u32 s59, s59, s38
s_add_u32 m0, s19, 65536
s_add_u32 s36, s59, 0
buffer_load_dwordx4 v148, s[32:35], s36 offen lds
s_add_u32 m0, s19, 66560
s_add_u32 s36, s59, 8192
buffer_load_dwordx4 v149, s[32:35], s36 offen lds
s_add_u32 m0, s19, 67584
s_add_u32 s36, s59, 16384
buffer_load_dwordx4 v148, s[32:35], s36 offen lds
s_add_u32 m0, s19, 68608
s_add_u32 s36, s59, 24576
buffer_load_dwordx4 v149, s[32:35], s36 offen lds
s_add_u32 m0, s19, 69632
s_add_u32 s36, s59, 32768
buffer_load_dwordx4 v148, s[32:35], s36 offen lds
s_add_u32 m0, s19, 70656
s_add_u32 s36, s59, 40960
buffer_load_dwordx4 v149, s[32:35], s36 offen lds
s_add_u32 m0, s19, 71680
s_add_u32 s36, s59, 49152
buffer_load_dwordx4 v148, s[32:35], s36 offen lds
s_add_u32 m0, s19, 72704
s_add_u32 s36, s59, 57344
buffer_load_dwordx4 v149, s[32:35], s36 offen lds
v_lshrrev_b32 v46, 4, v0
v_bfe_u32 v47, v0, 2, 2
v_lshl_add_u32 v48, v46, 3, v47
v_lshlrev_b32 v48, 7, v48
v_lshrrev_b32 v49, 1, v47
v_and_b32 v46, 1, v46
v_lshl_or_b32 v49, v46, 1, v49
v_lshlrev_b32 v49, 1, v49
v_bfe_u32 v46, v0, 1, 1
v_xor_b32 v49, v49, v46
v_lshl_add_u32 v48, v49, 4, v48
v_and_b32 v46, 1, v0
v_lshl_add_u32 v48, v46, 3, v48
s_lshl_b32 s68, s6, 14
s_add_u32 s68, s68, 0
v_add_u32 v48, s68, v48
v_xor_b32 v42, 0, v48
v_xor_b32 v43, 32, v48
v_xor_b32 v44, 64, v48
v_xor_b32 v45, 96, v48
ds_read_b64_tr_b16 v[192:193], v42 offset:0
ds_read_b64_tr_b16 v[194:195], v42 offset:512
ds_read_b64_tr_b16 v[196:197], v42 offset:4096
ds_read_b64_tr_b16 v[198:199], v42 offset:4608
ds_read_b64_tr_b16 v[200:201], v42 offset:8192
ds_read_b64_tr_b16 v[202:203], v42 offset:8704
ds_read_b64_tr_b16 v[204:205], v42 offset:12288
ds_read_b64_tr_b16 v[206:207], v42 offset:12800
ds_read_b64_tr_b16 v[208:209], v43 offset:0
ds_read_b64_tr_b16 v[210:211], v43 offset:512
ds_read_b64_tr_b16 v[212:213], v43 offset:4096
ds_read_b64_tr_b16 v[214:215], v43 offset:4608
ds_read_b64_tr_b16 v[216:217], v43 offset:8192
ds_read_b64_tr_b16 v[218:219], v43 offset:8704
ds_read_b64_tr_b16 v[220:221], v43 offset:12288
ds_read_b64_tr_b16 v[222:223], v43 offset:12800
ds_read_b64_tr_b16 v[224:225], v44 offset:0
ds_read_b64_tr_b16 v[226:227], v44 offset:512
ds_read_b64_tr_b16 v[228:229], v44 offset:4096
ds_read_b64_tr_b16 v[230:231], v44 offset:4608
ds_read_b64_tr_b16 v[232:233], v44 offset:8192
ds_read_b64_tr_b16 v[234:235], v44 offset:8704
ds_read_b64_tr_b16 v[236:237], v44 offset:12288
ds_read_b64_tr_b16 v[238:239], v44 offset:12800
ds_read_b64_tr_b16 v[240:241], v45 offset:0
ds_read_b64_tr_b16 v[242:243], v45 offset:512
ds_read_b64_tr_b16 v[244:245], v45 offset:4096
ds_read_b64_tr_b16 v[246:247], v45 offset:4608
ds_read_b64_tr_b16 v[248:249], v45 offset:8192
ds_read_b64_tr_b16 v[250:251], v45 offset:8704
ds_read_b64_tr_b16 v[252:253], v45 offset:12288
ds_read_b64_tr_b16 v[254:255], v45 offset:12800
v_mov_b32 v136, 0
v_mov_b32 v137, 0
v_mov_b32 v138, 0
v_mov_b32 v139, 0
s_mov_b64 exec, s[40:41]
v_mov_b32 v136, 0x3f803f80
v_mov_b32 v137, 0x3f803f80
v_mov_b32 v138, 0x3f803f80
v_mov_b32 v139, 0x3f803f80
s_mov_b64 exec, -1
s_waitcnt lgkmcnt(0)
v_mfma_f32_16x16x32_bf16 v[64:67], v[136:139], v[192:195], 0
v_mfma_f32_16x16x32_bf16 v[68:71], v[136:139], v[196:199], 0
v_mfma_f32_16x16x32_bf16 v[64:67], v[136:139], v[200:203], v[64:67]
v_mfma_f32_16x16x32_bf16 v[68:71], v[136:139], v[204:207], v[68:71]
v_mfma_f32_16x16x32_bf16 v[72:75], v[136:139], v[208:211], 0
v_mfma_f32_16x16x32_bf16 v[76:79], v[136:139], v[212:215], 0
v_mfma_f32_16x16x32_bf16 v[72:75], v[136:139], v[216:219], v[72:75]
v_mfma_f32_16x16x32_bf16 v[76:79], v[136:139], v[220:223], v[76:79]
v_mfma_f32_16x16x32_bf16 v[80:83], v[136:139], v[224:227], 0
s_nop 1
v_add_f32 v54, v64, v66
v_mfma_f32_16x16x32_bf16 v[84:87], v[136:139], v[228:231], 0
v_add_f32 v69, v69, v71
v_add_f32 v54, v54, v69
v_add_f32 v55, v72, v74
v_mfma_f32_16x16x32_bf16 v[80:83], v[136:139], v[232:235], v[80:83]
v_add_f32 v77, v77, v79
v_add_f32 v55, v55, v77
v_mfma_f32_16x16x32_bf16 v[84:87], v[136:139], v[236:239], v[84:87]
v_mfma_f32_16x16x32_bf16 v[88:91], v[136:139], v[240:243], 0
v_mfma_f32_16x16x32_bf16 v[92:95], v[136:139], v[244:247], 0
v_mfma_f32_16x16x32_bf16 v[88:91], v[136:139], v[248:251], v[88:91]
s_nop 1
v_add_f32 v56, v80, v82
v_mfma_f32_16x16x32_bf16 v[92:95], v[136:139], v[252:255], v[92:95]
s_nop 0
v_add_f32 v85, v85, v87
v_add_f32 v56, v56, v85
s_nop 0
v_add_f32 v57, v88, v90
v_permlane32_swap_b32 v54, v56
v_add_f32 v54, v54, v56
s_nop 0
v_add_f32 v93, v93, v95
v_add_f32 v57, v57, v93
s_nop 1
v_permlane32_swap_b32 v55, v57
v_add_f32 v55, v55, v57
s_nop 1
v_permlane16_swap_b32 v54, v55
v_add_f32 v54, v54, v55
ds_write_b32 v13, v54 offset:4096
Lw_22:
s_cmp_eq_u32 s77, 7
s_cbranch_scc1 Lg7_23
s_add_u32 s48, s46, 303104
s_addc_u32 s49, s47, 0
s_mov_b32 s56, 0
Lpoll_24:
global_load_dwordx4 v[32:35], v1, s[48:49] sc1
global_load_dwordx4 v[36:39], v1, s[48:49] offset:128 sc1
s_add_u32 s56, s56, 1
s_cmp_ge_u32 s56, 40000
s_cbranch_scc1 Lgot_25
s_waitcnt vmcnt(0)
v_mfma_f32_16x16x32_bf16 v[96:99], v[32:35], v[32:35], 0
v_max3_u32 v42, v32, v33, v34
v_max3_u32 v42, v42, v35, v36
v_max3_u32 v42, v42, v37, v38
v_mfma_f32_16x16x32_bf16 v[100:103], v[32:35], v[20:23], 0
v_max_u32 v42, v42, v39
v_cmp_eq_u32 vcc, -1, v42
v_mfma_f32_16x16x32_bf16 v[96:99], v[36:39], v[36:39], v[96:99]
v_mfma_f32_16x16x32_bf16 v[100:103], v[36:39], v[20:23], v[100:103]
s_cbranch_vccnz Lpoll_24
Lgot_25:
v_mfma_f32_16x16x32_bf16 v[64:67], v[32:35], v[192:195], 0
s_nop 4
v_add_f32 v96, v96, v98
v_add_f32 v97, v97, v99
v_cndmask_b32 v50, v96, v97, s[52:53]
v_mfma_f32_16x16x32_bf16 v[68:71], v[32:35], v[196:199], 0
v_add_f32 v100, v100, v101
v_add_f32_dpp v50, v50, v50 row_ror:8 row_mask:0xf bank_mask:0xf
v_add_f32 v102, v102, v103
v_mfma_f32_16x16x32_bf16 v[64:67], v[36:39], v[200:203], v[64:67]
v_add_f32_dpp v50, v50, v50 row_ror:4 row_mask:0xf bank_mask:0xf
v_add_f32 v51, v100, v102
v_mfma_f32_16x16x32_bf16 v[68:71], v[36:39], v[204:207], v[68:71]
v_add_f32_dpp v50, v50, v50 row_ror:2 row_mask:0xf bank_mask:0xf
v_mfma_f32_16x16x32_bf16 v[72:75], v[32:35], v[208:211], 0
s_nop 0
v_add_f32_dpp v50, v50, v50 row_ror:1 row_mask:0xf bank_mask:0xf
v_mfma_f32_16x16x32_bf16 v[76:79], v[32:35], v[212:215], 0
v_add_f32 v54, v64, v66
v_permlane32_swap_b32 v50, v51
v_add_f32 v50, v50, v51
v_mfma_f32_16x16x32_bf16 v[72:75], v[36:39], v[216:219], v[72:75]
v_add_f32 v69, v69, v71
v_add_f32 v54, v54, v69
v_mov_b32 v52, v50
v_mfma_f32_16x16x32_bf16 v[76:79], v[36:39], v[220:223], v[76:79]
s_nop 0
v_permlane16_swap_b32 v50, v52
v_add_f32 v50, v50, v52
v_mfma_f32_16x16x32_bf16 v[80:83], v[32:35], v[224:227], 0
v_add_f32 v55, v72, v74
v_mul_f32 v50, 0x3b000000, v50
v_mfma_f32_16x16x32_bf16 v[84:87], v[32:35], v[228:231], 0
s_nop 0
v_add_f32 v77, v77, v79
v_add_f32 v55, v55, v77
v_mfma_f32_16x16x32_bf16 v[80:83], v[36:39], v[232:235], v[80:83]
v_mfma_f32_16x16x32_bf16 v[84:87], v[36:39], v[236:239], v[84:87]
v_mfma_f32_16x16x32_bf16 v[88:91], v[32:35], v[240:243], 0
v_mfma_f32_16x16x32_bf16 v[92:95], v[32:35], v[244:247], 0
v_mfma_f32_16x16x32_bf16 v[88:91], v[36:39], v[248:251], v[88:91]
v_mfma_f32_16x16x32_bf16 v[92:95], v[36:39], v[252:255], v[92:95]
s_nop 2
v_add_f32 v56, v80, v82
v_add_f32 v85, v85, v87
v_add_f32 v56, v56, v85
s_nop 0
v_add_f32 v57, v88, v90
v_add_f32 v93, v93, v95
v_add_f32 v57, v57, v93
v_permlane32_swap_b32 v54, v56
v_add_f32 v54, v54, v56
v_permlane32_swap_b32 v55, v57
v_add_f32 v55, v55, v57
s_nop 1
v_permlane16_swap_b32 v54, v55
v_add_f32 v54, v54, v55
ds_write_b32 v13, v54 offset:3072
s_mov_b64 exec, s[60:61]
ds_write_b32 v24, v50 offset:64
s_mov_b64 exec, -1
s_waitcnt lgkmcnt(0)
s_barrier
s_cmp_lg_u32 s6, 3
s_cbranch_scc1 Lw_26
ds_read2st64_b32 v[42:43], v14 offset0:16 offset1:17
ds_read2st64_b32 v[44:45], v14 offset0:18 offset1:19
s_waitcnt lgkmcnt(0)
v_add_f32 v42, v42, v43
v_add_f32 v44, v44, v45
v_add_f32 v16, v42, v44
ds_read2st64_b32 v[42:43], v14 offset0:12 offset1:13
ds_read2st64_b32 v[44:45], v14 offset0:14 offset1:15
ds_read_b128 v[46:49], v29 offset:7232
ds_read_b128 v[50:53], v29 offset:7248
s_add_u32 s48, s46, 425984
s_addc_u32 s49, s47, 0
s_waitcnt lgkmcnt(0)
v_pk_add_f32 v[46:47], v[46:47], v[48:49]
v_pk_add_f32 v[50:51], v[50:51], v[52:53]
v_pk_add_f32 v[46:47], v[46:47], v[50:51]
v_fma_f32 v46, -v47, v47, v46
v_max_f32 v46, 0, v46
v_add_f32 v46, 0x3727c5ac, v46
v_add_f32 v42, v42, v43
v_add_f32 v44, v44, v45
v_rsq_f32 v46, v46
v_add_f32 v54, v42, v44
v_fma_f32 v54, -v47, v16, v54
v_mul_f32 v54, v54, v46
v_mov_b32 v55, v54
s_nop 1
v_permlane32_swap_b32 v54, v55
v_mul_f32 v54, 0xbfb8aa3b, v54
v_exp_f32 v54, v54
s_nop 0
v_add_f32 v54, 1.0, v54
v_rcp_f32 v54, v54
s_nop 0
v_mul_f32 v54, v54, v55
s_nop 1
v_mov_b32_dpp v43, v54 quad_perm:[1,1,3,3] row_mask:0xf bank_mask:0xf
v_cvt_pk_bf16_f32 v56, v54, v43
s_mov_b64 exec, s[54:55]
s_cmp_eq_u32 s7, 0
s_cbranch_scc1 Lsl_27
global_store_dword v10, v56, s[48:49]
s_branch Lse_28
Lsl_27:
global_store_dword v10, v56, s[48:49] sc1
Lse_28:
s_mov_b64 exec, -1
Lw_26:
Lg7_23:
s_cmp_lg_u32 s77, 7
s_cbranch_scc1 Ld7_29
s_waitcnt vmcnt(0)
Ld7_29:
v_lshrrev_b32 v46, 4, v0
v_bfe_u32 v47, v0, 2, 2
v_lshl_add_u32 v48, v46, 3, v47
v_lshlrev_b32 v48, 7, v48
v_lshrrev_b32 v49, 1, v47
v_and_b32 v46, 1, v46
v_lshl_or_b32 v49, v46, 1, v49
v_lshlrev_b32 v49, 1, v49
v_bfe_u32 v46, v0, 1, 1
v_xor_b32 v49, v49, v46
v_lshl_add_u32 v48, v49, 4, v48
v_and_b32 v46, 1, v0
v_lshl_add_u32 v48, v46, 3, v48
s_lshl_b32 s68, s6, 14
s_add_u32 s68, s68, 65536
v_add_u32 v48, s68, v48
v_xor_b32 v42, 0, v48
v_xor_b32 v43, 32, v48
v_xor_b32 v44, 64, v48
v_xor_b32 v45, 96, v48
ds_read_b64_tr_b16 v[160:161], v42 offset:0
ds_read_b64_tr_b16 v[162:163], v42 offset:512
ds_read_b64_tr_b16 v[164:165], v42 offset:4096
ds_read_b64_tr_b16 v[166:167], v42 offset:4608
ds_read_b64_tr_b16 v[168:169], v43 offset:0
ds_read_b64_tr_b16 v[170:171], v43 offset:512
ds_read_b64_tr_b16 v[172:173], v43 offset:4096
ds_read_b64_tr_b16 v[174:175], v43 offset:4608
ds_read_b64_tr_b16 v[176:177], v44 offset:0
ds_read_b64_tr_b16 v[178:179], v44 offset:512
ds_read_b64_tr_b16 v[180:181], v44 offset:4096
ds_read_b64_tr_b16 v[182:183], v44 offset:4608
ds_read_b64_tr_b16 v[184:185], v45 offset:0
ds_read_b64_tr_b16 v[186:187], v45 offset:512
ds_read_b64_tr_b16 v[188:189], v45 offset:4096
ds_read_b64_tr_b16 v[190:191], v45 offset:4608
s_waitcnt lgkmcnt(0)
v_mov_b32 v136, 0
v_mov_b32 v137, 0
v_mov_b32 v138, 0
v_mov_b32 v139, 0
s_mov_b64 exec, s[40:41]
v_mov_b32 v136, 0x3f803f80
v_mov_b32 v137, 0x3f803f80
v_mov_b32 v138, 0x3f803f80
v_mov_b32 v139, 0x3f803f80
s_mov_b64 exec, -1
s_nop 0
v_mfma_f32_16x16x32_bf16 v[64:67], v[136:139], a[128:131], 0
v_mfma_f32_16x16x32_bf16 v[68:71], v[136:139], a[132:135], 0
v_mfma_f32_16x16x32_bf16 v[64:67], v[136:139], a[136:139], v[64:67]
v_mfma_f32_16x16x32_bf16 v[68:71], v[136:139], a[140:143], v[68:71]
v_mfma_f32_16x16x32_bf16 v[72:75], v[136:139], a[144:147], 0
v_mfma_f32_16x16x32_bf16 v[76:79], v[136:139], a[148:151], 0
v_mfma_f32_16x16x32_bf16 v[72:75], v[136:139], a[152:155], v[72:75]
v_mfma_f32_16x16x32_bf16 v[76:79], v[136:139], a[156:159], v[76:79]
v_mfma_f32_16x16x32_bf16 v[80:83], v[136:139], a[160:163], 0
s_nop 1
v_add_f32 v54, v64, v66
v_mfma_f32_16x16x32_bf16 v[84:87], v[136:139], a[164:167], 0
v_add_f32 v69, v69, v71
v_add_f32 v54, v54, v69
v_add_f32 v55, v72, v74
v_mfma_f32_16x16x32_bf16 v[80:83], v[136:139], a[168:171], v[80:83]
v_add_f32 v77, v77, v79
v_add_f32 v55, v55, v77
v_mfma_f32_16x16x32_bf16 v[84:87], v[136:139], a[172:175], v[84:87]
v_mfma_f32_16x16x32_bf16 v[88:91], v[136:139], a[176:179], 0
v_mfma_f32_16x16x32_bf16 v[92:95], v[136:139], a[180:183], 0
v_mfma_f32_16x16x32_bf16 v[88:91], v[136:139], a[184:187], v[88:91]
s_nop 1
v_add_f32 v56, v80, v82
v_mfma_f32_16x16x32_bf16 v[92:95], v[136:139], a[188:191], v[92:95]
s_nop 0
v_add_f32 v85, v85, v87
v_add_f32 v56, v56, v85
s_nop 0
v_add_f32 v57, v88, v90
v_permlane32_swap_b32 v54, v56
v_add_f32 v54, v54, v56
s_nop 0
v_add_f32 v93, v93, v95
v_add_f32 v57, v57, v93
s_nop 1
v_permlane32_swap_b32 v55, v57
v_add_f32 v55, v55, v57
s_nop 1
v_permlane16_swap_b32 v54, v55
v_add_f32 v54, v54, v55
ds_write_b32 v13, v54 offset:1024
s_cmp_lg_u32 s6, 3
s_cbranch_scc1 Lw_30
v_mov_b32 v17, 0
s_cmp_lg_u32 s3, 0
s_cbranch_scc1 Lrs_31
s_lshl_b32 s38, s4, 13
s_lshl_b32 s39, s5, 7
s_add_u32 s38, s38, s39
v_lshlrev_b32 v62, 1, v0
v_add_u32 v62, s38, v62
s_add_u32 s48, s46, 303104
s_addc_u32 s49, s47, 0
v_add_u32 v50, 4096, v62
s_mov_b32 s56, 0
Lrv_32:
global_load_ushort v42, v62, s[48:49] offset:0 sc1
global_load_ushort v43, v62, s[48:49] offset:1024 sc1
global_load_ushort v44, v62, s[48:49] offset:2048 sc1
global_load_ushort v45, v62, s[48:49] offset:3072 sc1
global_load_ushort v46, v50, s[48:49] offset:0 sc1
global_load_ushort v47, v50, s[48:49] offset:1024 sc1
global_load_ushort v48, v50, s[48:49] offset:2048 sc1
global_load_ushort v49, v50, s[48:49] offset:3072 sc1
s_add_u32 s56, s56, 1
s_cmp_ge_u32 s56, 40000
s_cbranch_scc1 Lrd_33
s_waitcnt vmcnt(0)
v_max3_u32 v51, v42, v43, v44
v_max3_u32 v51, v51, v45, v46
v_max3_u32 v51, v51, v47, v48
v_max_u32 v51, v51, v49
v_cmp_eq_u32 vcc, 0xffff, v51
s_cbranch_vccnz Lrv_32
Lrd_33:
s_waitcnt vmcnt(0)
v_lshlrev_b32 v42, 16, v42
v_lshlrev_b32 v43, 16, v43
v_lshlrev_b32 v44, 16, v44
v_lshlrev_b32 v45, 16, v45
v_lshlrev_b32 v46, 16, v46
v_lshlrev_b32 v47, 16, v47
v_lshlrev_b32 v48, 16, v48
v_lshlrev_b32 v49, 16, v49
v_add_f32 v42, v42, v43
v_add_f32 v44, v44, v45
v_add_f32 v46, v46, v47
v_add_f32 v48, v48, v49
v_add_f32 v42, v42, v44
v_add_f32 v46, v46, v48
v_add_f32 v17, v42, v46
Lrs_31:
Lw_30:
v_mov_b32 v32, 0
v_mov_b32 v33, 0
v_mov_b32 v34, 0
v_mov_b32 v35, 0
s_add_u32 s48, s46, 425984
s_addc_u32 s49, s47, 0
s_mov_b64 exec, s[42:43]
s_mov_b32 s56, 0
Lpoll_34:
global_load_dwordx4 v[32:35], v4, s[48:49] sc1
s_add_u32 s56, s56, 1
s_cmp_ge_u32 s56, 40000
s_cbranch_scc1 Lgot_35
s_waitcnt vmcnt(0)
v_max3_u32 v42, v32, v33, v34
v_max_u32 v42, v42, v35
v_cmp_eq_u32 vcc, -1, v42
s_cbranch_vccnz Lpoll_34
Lgot_35:
s_waitcnt vmcnt(0)
s_mov_b64 exec, -1
v_mfma_f32_16x16x32_bf16 v[64:67], v[32:35], v[160:163], 0
s_mov_b32 s8, 0xffff
s_mov_b32 s9, 0
v_mfma_f32_16x16x32_bf16 v[68:71], v[32:35], v[164:167], 0
v_mfma_f32_16x16x32_bf16 v[72:75], v[32:35], v[168:171], 0
v_mfma_f32_16x16x32_bf16 v[76:79], v[32:35], v[172:175], 0
v_mfma_f32_16x16x32_bf16 v[80:83], v[32:35], v[176:179], 0
v_mfma_f32_16x16x32_bf16 v[84:87], v[32:35], v[180:183], 0
v_mfma_f32_16x16x32_bf16 v[88:91], v[32:35], v[184:187], 0
v_mfma_f32_16x16x32_bf16 v[92:95], v[32:35], v[188:191], 0
s_nop 1
v_add_f32 v54, v64, v69
s_nop 0
v_add_f32 v55, v72, v77
s_nop 0
v_add_f32 v56, v80, v85
s_nop 0
v_add_f32 v57, v88, v93
s_mov_b64 exec, s[8:9]
ds_write_b128 v27, v[54:57]
s_mov_b64 exec, -1
s_waitcnt lgkmcnt(0)
s_barrier
s_cmp_lg_u32 s6, 3
s_cbranch_scc1 Lw_36
ds_read2st64_b32 v[42:43], v28 offset0:0 offset1:1
ds_read2st64_b32 v[44:45], v28 offset0:2 offset1:3
s_waitcnt lgkmcnt(0)
v_add_f32 v42, v42, v43
v_add_f32 v44, v44, v45
v_add_f32 v54, v42, v44
v_add_f32 v54, v54, v17
s_add_u32 s48, s46, 352256
s_addc_u32 s49, s47, 0
v_mov_b32_dpp v43, v54 quad_perm:[1,1,3,3] row_mask:0xf bank_mask:0xf
v_cvt_pk_bf16_f32 v55, v54, v43
s_mov_b64 exec, s[50:51]
global_store_dword v11, v55, s[48:49] sc1
s_mov_b64 exec, -1
ds_read2st64_b32 v[42:43], v14 offset0:4 offset1:5
ds_read2st64_b32 v[44:45], v14 offset0:6 offset1:7
s_waitcnt lgkmcnt(0)
v_add_f32 v42, v42, v43
v_add_f32 v44, v44, v45
v_add_f32 v15, v42, v44
Lw_36:
s_add_u32 s46, s46, 524288
s_addc_u32 s47, s47, 0
s_cmp_eq_u32 s6, 3
s_cbranch_scc1 Lxd_37
s_sleep 5
Lxd_37:
s_sub_u32 s48, s46, 172032
s_subb_u32 s49, s47, 0
s_sleep 6
s_mov_b32 s56, 0
Lpoll_38:
global_load_dwordx4 v[32:35], v1, s[48:49] sc1
global_load_dwordx4 v[36:39], v1, s[48:49] offset:128 sc1
s_add_u32 s56, s56, 1
s_cmp_ge_u32 s56, 40000
s_cbranch_scc1 Lgot_39
s_waitcnt vmcnt(0)
v_mfma_f32_16x16x32_bf16 v[96:99], v[32:35], v[32:35], 0
v_max3_u32 v42, v32, v33, v34
v_max3_u32 v42, v42, v35, v36
v_max3_u32 v42, v42, v37, v38
v_mfma_f32_16x16x32_bf16 v[100:103], v[32:35], v[20:23], 0
v_max_u32 v42, v42, v39
v_cmp_eq_u32 vcc, -1, v42
v_mfma_f32_16x16x32_bf16 v[96:99], v[36:39], v[36:39], v[96:99]
v_mfma_f32_16x16x32_bf16 v[100:103], v[36:39], v[20:23], v[100:103]
s_cbranch_vccnz Lpoll_38
Lgot_39:
v_mfma_f32_16x16x32_bf16 v[64:67], v[32:35], a[128:131], 0
s_nop 4
v_add_f32 v96, v96, v98
v_add_f32 v97, v97, v99
v_cndmask_b32 v50, v96, v97, s[52:53]
v_mfma_f32_16x16x32_bf16 v[68:71], v[32:35], a[132:135], 0
v_add_f32 v100, v100, v101
v_add_f32_dpp v50, v50, v50 row_ror:8 row_mask:0xf bank_mask:0xf
v_add_f32 v102, v102, v103
v_mfma_f32_16x16x32_bf16 v[64:67], v[36:39], a[136:139], v[64:67]
v_add_f32_dpp v50, v50, v50 row_ror:4 row_mask:0xf bank_mask:0xf
v_add_f32 v51, v100, v102
v_mfma_f32_16x16x32_bf16 v[68:71], v[36:39], a[140:143], v[68:71]
v_add_f32_dpp v50, v50, v50 row_ror:2 row_mask:0xf bank_mask:0xf
v_mfma_f32_16x16x32_bf16 v[72:75], v[32:35], a[144:147], 0
s_nop 0
v_add_f32_dpp v50, v50, v50 row_ror:1 row_mask:0xf bank_mask:0xf
v_mfma_f32_16x16x32_bf16 v[76:79], v[32:35], a[148:151], 0
v_add_f32 v54, v64, v66
v_permlane32_swap_b32 v50, v51
v_add_f32 v50, v50, v51
v_mfma_f32_16x16x32_bf16 v[72:75], v[36:39], a[152:155], v[72:75]
v_add_f32 v69, v69, v71
v_add_f32 v54, v54, v69
v_mov_b32 v52, v50
v_mfma_f32_16x16x32_bf16 v[76:79], v[36:39], a[156:159], v[76:79]
s_nop 0
v_permlane16_swap_b32 v50, v52
v_add_f32 v50, v50, v52
v_mfma_f32_16x16x32_bf16 v[80:83], v[32:35], a[160:163], 0
v_add_f32 v55, v72, v74
v_mul_f32 v50, 0x3b000000, v50
v_mfma_f32_16x16x32_bf16 v[84:87], v[32:35], a[164:167], 0
s_nop 0
v_add_f32 v77, v77, v79
v_add_f32 v55, v55, v77
v_mfma_f32_16x16x32_bf16 v[80:83], v[36:39], a[168:171], v[80:83]
v_mfma_f32_16x16x32_bf16 v[84:87], v[36:39], a[172:175], v[84:87]
v_mfma_f32_16x16x32_bf16 v[88:91], v[32:35], a[176:179], 0
v_mfma_f32_16x16x32_bf16 v[92:95], v[32:35], a[180:183], 0
v_mfma_f32_16x16x32_bf16 v[88:91], v[36:39], a[184:187], v[88:91]
v_mfma_f32_16x16x32_bf16 v[92:95], v[36:39], a[188:191], v[92:95]
s_nop 2
v_add_f32 v56, v80, v82
v_add_f32 v85, v85, v87
v_add_f32 v56, v56, v85
s_nop 0
v_add_f32 v57, v88, v90
v_add_f32 v93, v93, v95
v_add_f32 v57, v57, v93
v_permlane32_swap_b32 v54, v56
v_add_f32 v54, v54, v56
v_permlane32_swap_b32 v55, v57
v_add_f32 v55, v55, v57
s_nop 1
v_permlane16_swap_b32 v54, v55
v_add_f32 v54, v54, v55
ds_write_b32 v13, v54 offset:0
s_mov_b64 exec, s[60:61]
ds_write_b32 v24, v50 offset:0
s_mov_b64 exec, -1
s_waitcnt lgkmcnt(0)
s_barrier
s_cmp_lg_u32 s6, 3
s_cbranch_scc1 Lw_40
ds_read2st64_b32 v[42:43], v14 offset0:0 offset1:1
ds_read2st64_b32 v[44:45], v14 offset0:2 offset1:3
ds_read_b128 v[46:49], v29 offset:7168
ds_read_b128 v[50:53], v29 offset:7184
s_add_u32 s48, s46, 0
s_addc_u32 s49, s47, 0
s_waitcnt lgkmcnt(0)
v_pk_add_f32 v[46:47], v[46:47], v[48:49]
v_pk_add_f32 v[50:51], v[50:51], v[52:53]
v_pk_add_f32 v[46:47], v[46:47], v[50:51]
v_fma_f32 v46, -v47, v47, v46
v_max_f32 v46, 0, v46
v_add_f32 v46, 0x3727c5ac, v46
v_add_f32 v42, v42, v43
v_add_f32 v44, v44, v45
v_rsq_f32 v46, v46
v_add_f32 v54, v42, v44
v_fma_f32 v54, -v47, v15, v54
v_mul_f32 v54, v54, v46
s_nop 1
v_mov_b32_dpp v43, v54 quad_perm:[1,1,3,3] row_mask:0xf bank_mask:0xf
v_cvt_pk_bf16_f32 v55, v54, v43
s_mov_b64 exec, s[50:51]
s_cmp_eq_u32 s7, 0
s_cbranch_scc1 Lsl_41
global_store_dword v6, v55, s[48:49]
s_branch Lse_42
Lsl_41:
global_store_dword v6, v55, s[48:49] sc1
Lse_42:
s_mov_b64 exec, -1
v_mov_b32 v17, 0
s_cmp_lg_u32 s3, 0
s_cbranch_scc1 Lrg_43
s_lshl_b32 s38, s4, 13
s_lshl_b32 s39, s5, 7
s_add_u32 s38, s38, s39
v_lshlrev_b32 v62, 1, v0
v_add_u32 v62, s38, v62
s_sub_u32 s48, s46, 172032
s_subb_u32 s49, s47, 0
v_add_u32 v50, 4096, v62
global_load_ushort v42, v62, s[48:49] offset:0 sc1
global_load_ushort v43, v62, s[48:49] offset:1024 sc1
global_load_ushort v44, v62, s[48:49] offset:2048 sc1
global_load_ushort v45, v62, s[48:49] offset:3072 sc1
global_load_ushort v46, v50, s[48:49] offset:0 sc1
global_load_ushort v47, v50, s[48:49] offset:1024 sc1
global_load_ushort v48, v50, s[48:49] offset:2048 sc1
global_load_ushort v49, v50, s[48:49] offset:3072 sc1
s_waitcnt vmcnt(0)
v_lshlrev_b32 v42, 16, v42
v_lshlrev_b32 v43, 16, v43
v_lshlrev_b32 v44, 16, v44
v_lshlrev_b32 v45, 16, v45
v_lshlrev_b32 v46, 16, v46
v_lshlrev_b32 v47, 16, v47
v_lshlrev_b32 v48, 16, v48
v_lshlrev_b32 v49, 16, v49
v_add_f32 v42, v42, v43
v_add_f32 v44, v44, v45
v_add_f32 v46, v46, v47
v_add_f32 v48, v48, v49
v_add_f32 v42, v42, v44
v_add_f32 v46, v46, v48
v_add_f32 v17, v42, v46
Lrg_43:
Lw_40:
s_cmp_eq_u32 s6, 3
s_cbranch_scc1 Lxd_44
s_sleep 4
Lxd_44:
s_add_u32 s48, s46, 0
s_addc_u32 s49, s47, 0
s_mov_b64 exec, s[44:45]
s_mov_b32 s56, 0
Lpoll_45:
global_load_dwordx4 v[64:67], v5, s[48:49] offset:0 sc1
global_load_dwordx4 v[68:71], v5, s[48:49] offset:256 sc1
global_load_dwordx4 v[72:75], v5, s[48:49] offset:512 sc1
global_load_dwordx4 v[76:79], v5, s[48:49] offset:768 sc1
s_add_u32 s56, s56, 1
s_cmp_ge_u32 s56, 40000
s_cbranch_scc1 Lgot_46
s_waitcnt vmcnt(0)
v_max3_u32 v42, v64, v65, v66
v_max3_u32 v42, v42, v67, v68
v_max3_u32 v42, v42, v69, v70
v_max3_u32 v42, v42, v71, v72
v_max3_u32 v42, v42, v73, v74
v_max3_u32 v42, v42, v75, v76
v_max3_u32 v42, v42, v77, v78
v_max_u32 v42, v42, v79
v_cmp_eq_u32 vcc, -1, v42
s_cbranch_vccnz Lpoll_45
Lgot_46:
s_waitcnt vmcnt(0)
s_mov_b64 exec, -1
v_mfma_f32_16x16x32_bf16 v[80:83], a[0:3], v[64:67], 0
v_mfma_f32_16x16x32_bf16 v[80:83], a[4:7], v[68:71], v[80:83]
v_mfma_f32_16x16x32_bf16 v[80:83], a[8:11], v[72:75], v[80:83]
v_mfma_f32_16x16x32_bf16 v[80:83], a[12:15], v[76:79], v[80:83]
v_mfma_f32_16x16x32_bf16 v[84:87], a[16:19], v[64:67], 0
v_mfma_f32_16x16x32_bf16 v[84:87], a[20:23], v[68:71], v[84:87]
v_mfma_f32_16x16x32_bf16 v[84:87], a[24:27], v[72:75], v[84:87]
v_mfma_f32_16x16x32_bf16 v[84:87], a[28:31], v[76:79], v[84:87]
v_mfma_f32_16x16x32_bf16 v[88:91], a[32:35], v[64:67], 0
v_mfma_f32_16x16x32_bf16 v[88:91], a[36:39], v[68:71], v[88:91]
s_nop 1
v_max3_f32 v42, v80, v81, v82
v_mfma_f32_16x16x32_bf16 v[88:91], a[40:43], v[72:75], v[88:91]
s_nop 1
v_max3_f32 v42, v42, v83, v84
v_mfma_f32_16x16x32_bf16 v[88:91], a[44:47], v[76:79], v[88:91]
v_max3_f32 v42, v42, v85, v86
v_mfma_f32_16x16x32_bf16 v[92:95], a[48:51], v[64:67], 0
v_mfma_f32_16x16x32_bf16 v[92:95], a[52:55], v[68:71], v[92:95]
v_mfma_f32_16x16x32_bf16 v[92:95], a[56:59], v[72:75], v[92:95]
v_mfma_f32_16x16x32_bf16 v[92:95], a[60:63], v[76:79], v[92:95]
s_nop 2
v_max3_f32 v42, v42, v87, v88
v_max3_f32 v42, v42, v89, v90
s_nop 2
v_max3_f32 v42, v42, v91, v92
v_max3_f32 v42, v42, v93, v94
v_max_f32 v42, v42, v95
v_mov_b32 v43, v42
s_nop 1
v_permlane32_swap_b32 v42, v43
v_max_f32 v42, v42, v43
v_mov_b32 v43, v42
s_nop 1
v_permlane16_swap_b32 v42, v43
v_max_f32 v42, v42, v43
v_mul_f32 v62, s18, v42
v_pk_fma_f32 v[80:81], v[80:81], s[78:79], v[62:63] op_sel_hi:[1,1,0] neg_lo:[0,0,1] neg_hi:[0,0,1]
v_pk_fma_f32 v[82:83], v[82:83], s[78:79], v[62:63] op_sel_hi:[1,1,0] neg_lo:[0,0,1] neg_hi:[0,0,1]
v_pk_fma_f32 v[84:85], v[84:85], s[78:79], v[62:63] op_sel_hi:[1,1,0] neg_lo:[0,0,1] neg_hi:[0,0,1]
v_pk_fma_f32 v[86:87], v[86:87], s[78:79], v[62:63] op_sel_hi:[1,1,0] neg_lo:[0,0,1] neg_hi:[0,0,1]
v_exp_f32 v80, v80
v_exp_f32 v81, v81
v_exp_f32 v82, v82
v_exp_f32 v83, v83
v_exp_f32 v84, v84
v_exp_f32 v85, v85
v_exp_f32 v86, v86
v_exp_f32 v87, v87
v_cvt_pk_bf16_f32 v96, v80, v81
v_cvt_pk_bf16_f32 v97, v82, v83
v_cvt_pk_bf16_f32 v98, v84, v85
v_cvt_pk_bf16_f32 v99, v86, v87
v_pk_fma_f32 v[88:89], v[88:89], s[78:79], v[62:63] op_sel_hi:[1,1,0] neg_lo:[0,0,1] neg_hi:[0,0,1]
v_pk_fma_f32 v[90:91], v[90:91], s[78:79], v[62:63] op_sel_hi:[1,1,0] neg_lo:[0,0,1] neg_hi:[0,0,1]
v_mfma_f32_16x16x32_bf16 v[136:139], v[20:23], v[96:99], 0
v_pk_fma_f32 v[92:93], v[92:93], s[78:79], v[62:63] op_sel_hi:[1,1,0] neg_lo:[0,0,1] neg_hi:[0,0,1]
v_pk_fma_f32 v[94:95], v[94:95], s[78:79], v[62:63] op_sel_hi:[1,1,0] neg_lo:[0,0,1] neg_hi:[0,0,1]
v_exp_f32 v88, v88
v_mfma_f32_16x16x32_bf16 v[104:107], a[64:67], v[96:99], 0
v_exp_f32 v89, v89
v_exp_f32 v90, v90
v_mfma_f32_16x16x32_bf16 v[108:111], a[68:71], v[96:99], 0
v_exp_f32 v91, v91
v_exp_f32 v92, v92
v_mfma_f32_16x16x32_bf16 v[112:115], a[72:75], v[96:99], 0
v_exp_f32 v93, v93
v_exp_f32 v94, v94
v_mfma_f32_16x16x32_bf16 v[116:119], a[76:79], v[96:99], 0
v_exp_f32 v95, v95
v_cvt_pk_bf16_f32 v100, v88, v89
v_mfma_f32_16x16x32_bf16 v[120:123], a[80:83], v[96:99], 0
v_cvt_pk_bf16_f32 v101, v90, v91
v_cvt_pk_bf16_f32 v102, v92, v93
v_cvt_pk_bf16_f32 v103, v94, v95
v_mfma_f32_16x16x32_bf16 v[124:127], a[84:87], v[96:99], 0
v_mfma_f32_16x16x32_bf16 v[128:131], a[88:91], v[96:99], 0
v_mfma_f32_16x16x32_bf16 v[132:135], a[92:95], v[96:99], 0
v_mfma_f32_16x16x32_bf16 v[136:139], v[20:23], v[100:103], v[136:139]
v_mfma_f32_16x16x32_bf16 v[104:107], a[96:99], v[100:103], v[104:107]
v_mfma_f32_16x16x32_bf16 v[108:111], a[100:103], v[100:103], v[108:111]
v_mfma_f32_16x16x32_bf16 v[112:115], a[104:107], v[100:103], v[112:115]
v_mfma_f32_16x16x32_bf16 v[116:119], a[108:111], v[100:103], v[116:119]
v_mfma_f32_16x16x32_bf16 v[120:123], a[112:115], v[100:103], v[120:123]
v_mfma_f32_16x16x32_bf16 v[124:127], a[116:119], v[100:103], v[124:127]
s_nop 1
v_mov_b32 v63, v136
v_mfma_f32_16x16x32_bf16 v[128:131], a[120:123], v[100:103], v[128:131]
v_mfma_f32_16x16x32_bf16 v[132:135], a[124:127], v[100:103], v[132:135]
s_mov_b64 exec, s[44:45]
ds_write_b128 v18, v[104:107] offset:0
ds_write_b128 v18, v[108:111] offset:64
ds_write_b128 v18, v[112:115] offset:128
ds_write_b128 v18, v[116:119] offset:192
ds_write_b128 v18, v[120:123] offset:256
ds_write_b128 v18, v[124:127] offset:320
ds_write_b128 v18, v[128:131] offset:384
ds_write_b128 v18, v[132:135] offset:448
s_mov_b64 exec, s[62:63]
ds_write_b64 v25, v[62:63]
s_mov_b64 exec, -1
s_waitcnt lgkmcnt(0)
s_barrier
ds_read_b128 v[46:49], v26
ds_read_b128 v[50:53], v26 offset:16
ds_read_b64 v[54:55], v19 offset:0
ds_read_b64 v[56:57], v19 offset:2112
ds_read_b64 v[58:59], v19 offset:4224
ds_read_b64 v[60:61], v19 offset:6336
s_add_u32 s48, s46, 32768
s_addc_u32 s49, s47, 0
s_waitcnt lgkmcnt(4)
v_max3_f32 v42, v46, v48, v50
v_max_f32 v42, v42, v52
v_sub_f32 v46, v46, v42
v_sub_f32 v48, v48, v42
v_exp_f32 v46, v46
v_sub_f32 v50, v50, v42
v_exp_f32 v48, v48
s_waitcnt lgkmcnt(0)
v_sub_f32 v52, v52, v42
v_exp_f32 v50, v50
v_mul_f32 v44, v46, v54
v_mul_f32 v45, v46, v55
v_exp_f32 v52, v52
v_mul_f32 v43, v46, v47
v_fmac_f32 v44, v48, v56
v_fmac_f32 v45, v48, v57
v_fmac_f32 v43, v48, v49
v_fmac_f32 v44, v50, v58
v_fmac_f32 v45, v50, v59
v_fmac_f32 v43, v50, v51
v_fmac_f32 v44, v52, v60
v_fmac_f32 v45, v52, v61
v_fmac_f32 v43, v52, v53
v_cvt_pk_bf16_f32 v44, v44, v45
s_cmp_eq_u32 s7, 0
s_cbranch_scc1 Lsl_47
global_store_dword v7, v44, s[48:49]
s_branch Lse_48
Lsl_47:
global_store_dword v7, v44, s[48:49] sc1
Lse_48:
s_add_u32 s48, s46, 294912
s_addc_u32 s49, s47, 0
s_mov_b64 exec, 1
s_cmp_eq_u32 s7, 0
s_cbranch_scc1 Lsl_49
global_store_dwordx2 v8, v[42:43], s[48:49]
s_branch Lse_50
Lsl_49:
global_store_dwordx2 v8, v[42:43], s[48:49] sc1
Lse_50:
s_mov_b64 exec, -1
s_add_u32 s48, s46, 32768
s_addc_u32 s49, s47, 0
s_add_u32 s8, s46, 294912
s_addc_u32 s9, s47, 0
s_mov_b32 s56, 0
Lpoll_51:
global_load_dwordx4 v[32:35], v2, s[48:49] sc1
global_load_dwordx4 v[36:39], v2, s[48:49] offset:128 sc1
global_load_dwordx2 v[40:41], v3, s[8:9] sc1
s_add_u32 s56, s56, 1
s_cmp_ge_u32 s56, 40000
s_cbranch_scc1 Lgot_52
s_waitcnt vmcnt(0)
v_mfma_f32_16x16x32_bf16 v[64:67], v[32:35], a[192:195], 0
v_max3_u32 v42, v32, v33, v34
v_max3_u32 v42, v42, v35, v36
v_max3_u32 v42, v42, v37, v38
v_mfma_f32_16x16x32_bf16 v[68:71], v[32:35], a[196:199], 0
v_max3_u32 v42, v42, v39, v40
v_max_u32 v42, v42, v41
v_cmp_eq_u32 vcc, -1, v42
v_mfma_f32_16x16x32_bf16 v[64:67], v[36:39], a[200:203], v[64:67]
v_mfma_f32_16x16x32_bf16 v[68:71], v[36:39], a[204:207], v[68:71]
s_cbranch_vccnz Lpoll_51
Lgot_52:
v_mfma_f32_16x16x32_bf16 v[72:75], v[32:35], a[208:211], 0
v_max_f32_dpp v58, v40, v40 row_ror:4 row_mask:0xf bank_mask:0xf
s_nop 4
v_add_f32 v64, v64, v69
v_add_f32 v66, v66, v71
v_mfma_f32_16x16x32_bf16 v[76:79], v[32:35], a[212:215], 0
v_max_f32_dpp v58, v58, v58 row_ror:2 row_mask:0xf bank_mask:0xf
v_mfma_f32_16x16x32_bf16 v[72:75], v[36:39], a[216:219], v[72:75]
s_nop 0
v_max_f32_dpp v58, v58, v58 row_ror:1 row_mask:0xf bank_mask:0xf
v_sub_f32 v59, v40, v58
v_mfma_f32_16x16x32_bf16 v[76:79], v[36:39], a[220:223], v[76:79]
v_exp_f32 v59, v59
v_mfma_f32_16x16x32_bf16 v[80:83], v[32:35], a[224:227], 0
v_mul_f32 v60, v59, v41
v_mfma_f32_16x16x32_bf16 v[84:87], v[32:35], a[228:231], 0
s_nop 0
v_add_f32_dpp v60, v60, v60 row_ror:4 row_mask:0xf bank_mask:0xf
v_mfma_f32_16x16x32_bf16 v[80:83], v[36:39], a[232:235], v[80:83]
s_nop 0
v_add_f32_dpp v60, v60, v60 row_ror:2 row_mask:0xf bank_mask:0xf
v_add_f32 v72, v72, v77
v_mfma_f32_16x16x32_bf16 v[84:87], v[36:39], a[236:239], v[84:87]
v_add_f32_dpp v60, v60, v60 row_ror:1 row_mask:0xf bank_mask:0xf
v_rcp_f32 v60, v60
v_mfma_f32_16x16x32_bf16 v[88:91], v[32:35], a[240:243], 0
v_mul_f32 v59, v59, v60
v_add_f32 v74, v74, v79
v_mfma_f32_16x16x32_bf16 v[92:95], v[32:35], a[244:247], 0
v_mov_b32_dpp v61, v59 row_newbcast:0 row_mask:0xf bank_mask:0xf
v_mov_b32_dpp v62, v59 row_newbcast:1 row_mask:0xf bank_mask:0xf
v_add_f32 v80, v80, v85
v_mfma_f32_16x16x32_bf16 v[88:91], v[36:39], a[248:251], v[88:91]
v_mul_f32 v54, v61, v64
v_mul_f32 v55, v61, v72
v_add_f32 v82, v82, v87
v_mfma_f32_16x16x32_bf16 v[92:95], v[36:39], a[252:255], v[92:95]
v_mul_f32 v56, v61, v80
v_fmac_f32 v54, v62, v66
v_fmac_f32 v55, v62, v74
v_fmac_f32 v56, v62, v82
s_nop 1
v_permlane32_swap_b32 v54, v56
v_add_f32 v54, v54, v56
v_add_f32 v88, v88, v93
v_add_f32 v90, v90, v95
v_mul_f32 v57, v61, v88
v_fmac_f32 v57, v62, v90
s_nop 1
v_permlane32_swap_b32 v55, v57
v_add_f32 v55, v55, v57
s_nop 1
v_permlane16_swap_b32 v54, v55
v_add_f32 v54, v54, v55
ds_write_b32 v13, v54 offset:2048
s_waitcnt lgkmcnt(0)
s_barrier
s_cmp_lg_u32 s6, 3
s_cbranch_scc1 Lw_53
ds_read2st64_b32 v[42:43], v14 offset0:8 offset1:9
ds_read2st64_b32 v[44:45], v14 offset0:10 offset1:11
s_add_u32 s48, s46, 303104
s_addc_u32 s49, s47, 0
s_waitcnt lgkmcnt(0)
v_add_f32 v42, v42, v43
v_add_f32 v44, v44, v45
v_add_f32 v54, v42, v44
v_add_f32 v54, v54, v17
s_nop 1
v_mov_b32_dpp v43, v54 quad_perm:[1,1,3,3] row_mask:0xf bank_mask:0xf
v_cvt_pk_bf16_f32 v55, v54, v43
s_mov_b64 exec, s[50:51]
global_store_dword v9, v55, s[48:49] sc1
s_mov_b64 exec, -1
v_mov_b32 v17, 0
Lw_53:
s_cmp_eq_u32 s77, 7
s_cbranch_scc1 Lg7_54
s_add_u32 s48, s46, 303104
s_addc_u32 s49, s47, 0
s_cmp_eq_u32 s6, 3
s_cbranch_scc1 Lxd_55
s_sleep 4
Lxd_55:
s_sleep 6
s_mov_b32 s56, 0
Lpoll_56:
global_load_dwordx4 v[32:35], v1, s[48:49] sc1
global_load_dwordx4 v[36:39], v1, s[48:49] offset:128 sc1
s_add_u32 s56, s56, 1
s_cmp_ge_u32 s56, 40000
s_cbranch_scc1 Lgot_57
s_waitcnt vmcnt(0)
v_mfma_f32_16x16x32_bf16 v[96:99], v[32:35], v[32:35], 0
v_max3_u32 v42, v32, v33, v34
v_max3_u32 v42, v42, v35, v36
v_max3_u32 v42, v42, v37, v38
v_mfma_f32_16x16x32_bf16 v[100:103], v[32:35], v[20:23], 0
v_max_u32 v42, v42, v39
v_cmp_eq_u32 vcc, -1, v42
v_mfma_f32_16x16x32_bf16 v[96:99], v[36:39], v[36:39], v[96:99]
v_mfma_f32_16x16x32_bf16 v[100:103], v[36:39], v[20:23], v[100:103]
s_cbranch_vccnz Lpoll_56
Lgot_57:
v_mfma_f32_16x16x32_bf16 v[64:67], v[32:35], v[192:195], 0
s_nop 4
v_add_f32 v96, v96, v98
v_add_f32 v97, v97, v99
v_cndmask_b32 v50, v96, v97, s[52:53]
v_mfma_f32_16x16x32_bf16 v[68:71], v[32:35], v[196:199], 0
v_add_f32 v100, v100, v101
v_add_f32_dpp v50, v50, v50 row_ror:8 row_mask:0xf bank_mask:0xf
v_add_f32 v102, v102, v103
v_mfma_f32_16x16x32_bf16 v[64:67], v[36:39], v[200:203], v[64:67]
v_add_f32_dpp v50, v50, v50 row_ror:4 row_mask:0xf bank_mask:0xf
v_add_f32 v51, v100, v102
v_mfma_f32_16x16x32_bf16 v[68:71], v[36:39], v[204:207], v[68:71]
v_add_f32_dpp v50, v50, v50 row_ror:2 row_mask:0xf bank_mask:0xf
v_mfma_f32_16x16x32_bf16 v[72:75], v[32:35], v[208:211], 0
s_nop 0
v_add_f32_dpp v50, v50, v50 row_ror:1 row_mask:0xf bank_mask:0xf
v_mfma_f32_16x16x32_bf16 v[76:79], v[32:35], v[212:215], 0
v_add_f32 v54, v64, v66
v_permlane32_swap_b32 v50, v51
v_add_f32 v50, v50, v51
v_mfma_f32_16x16x32_bf16 v[72:75], v[36:39], v[216:219], v[72:75]
v_add_f32 v69, v69, v71
v_add_f32 v54, v54, v69
v_mov_b32 v52, v50
v_mfma_f32_16x16x32_bf16 v[76:79], v[36:39], v[220:223], v[76:79]
s_nop 0
v_permlane16_swap_b32 v50, v52
v_add_f32 v50, v50, v52
v_mfma_f32_16x16x32_bf16 v[80:83], v[32:35], v[224:227], 0
v_add_f32 v55, v72, v74
v_mul_f32 v50, 0x3b000000, v50
v_mfma_f32_16x16x32_bf16 v[84:87], v[32:35], v[228:231], 0
s_nop 0
v_add_f32 v77, v77, v79
v_add_f32 v55, v55, v77
v_mfma_f32_16x16x32_bf16 v[80:83], v[36:39], v[232:235], v[80:83]
v_mfma_f32_16x16x32_bf16 v[84:87], v[36:39], v[236:239], v[84:87]
v_mfma_f32_16x16x32_bf16 v[88:91], v[32:35], v[240:243], 0
v_mfma_f32_16x16x32_bf16 v[92:95], v[32:35], v[244:247], 0
v_mfma_f32_16x16x32_bf16 v[88:91], v[36:39], v[248:251], v[88:91]
v_mfma_f32_16x16x32_bf16 v[92:95], v[36:39], v[252:255], v[92:95]
s_nop 2
v_add_f32 v56, v80, v82
v_add_f32 v85, v85, v87
v_add_f32 v56, v56, v85
s_nop 0
v_add_f32 v57, v88, v90
v_add_f32 v93, v93, v95
v_add_f32 v57, v57, v93
v_permlane32_swap_b32 v54, v56
v_add_f32 v54, v54, v56
v_permlane32_swap_b32 v55, v57
v_add_f32 v55, v55, v57
s_nop 1
v_permlane16_swap_b32 v54, v55
v_add_f32 v54, v54, v55
ds_write_b32 v13, v54 offset:3072
s_mov_b64 exec, s[60:61]
ds_write_b32 v24, v50 offset:64
s_mov_b64 exec, -1
s_waitcnt lgkmcnt(0)
s_barrier
s_cmp_lg_u32 s6, 3
s_cbranch_scc1 Lw_58
ds_read2st64_b32 v[42:43], v14 offset0:12 offset1:13
ds_read2st64_b32 v[44:45], v14 offset0:14 offset1:15
ds_read_b128 v[46:49], v29 offset:7232
ds_read_b128 v[50:53], v29 offset:7248
s_add_u32 s48, s46, 425984
s_addc_u32 s49, s47, 0
s_waitcnt lgkmcnt(0)
v_pk_add_f32 v[46:47], v[46:47], v[48:49]
v_pk_add_f32 v[50:51], v[50:51], v[52:53]
v_pk_add_f32 v[46:47], v[46:47], v[50:51]
v_fma_f32 v46, -v47, v47, v46
v_max_f32 v46, 0, v46
v_add_f32 v46, 0x3727c5ac, v46
v_add_f32 v42, v42, v43
v_add_f32 v44, v44, v45
v_rsq_f32 v46, v46
v_add_f32 v54, v42, v44
v_fma_f32 v54, -v47, v16, v54
v_mul_f32 v54, v54, v46
v_mov_b32 v55, v54
s_nop 1
v_permlane32_swap_b32 v54, v55
v_mul_f32 v54, 0xbfb8aa3b, v54
v_exp_f32 v54, v54
s_nop 0
v_add_f32 v54, 1.0, v54
v_rcp_f32 v54, v54
s_nop 0
v_mul_f32 v54, v54, v55
s_nop 1
v_mov_b32_dpp v43, v54 quad_perm:[1,1,3,3] row_mask:0xf bank_mask:0xf
v_cvt_pk_bf16_f32 v56, v54, v43
s_mov_b64 exec, s[54:55]
s_cmp_eq_u32 s7, 0
s_cbranch_scc1 Lsl_59
global_store_dword v10, v56, s[48:49]
s_branch Lse_60
Lsl_59:
global_store_dword v10, v56, s[48:49] sc1
Lse_60:
s_mov_b64 exec, -1
Lw_58:
Lg7_54:
s_cmp_lg_u32 s6, 3
s_cbranch_scc1 Lw_61
v_mov_b32 v17, 0
s_cmp_lg_u32 s3, 0
s_cbranch_scc1 Lrs_62
s_lshl_b32 s38, s4, 13
s_lshl_b32 s39, s5, 7
s_add_u32 s38, s38, s39
v_lshlrev_b32 v62, 1, v0
v_add_u32 v62, s38, v62
s_add_u32 s48, s46, 303104
s_addc_u32 s49, s47, 0
v_add_u32 v50, 4096, v62
s_mov_b32 s56, 0
Lrv_63:
global_load_ushort v42, v62, s[48:49] offset:0 sc1
global_load_ushort v43, v62, s[48:49] offset:1024 sc1
global_load_ushort v44, v62, s[48:49] offset:2048 sc1
global_load_ushort v45, v62, s[48:49] offset:3072 sc1
global_load_ushort v46, v50, s[48:49] offset:0 sc1
global_load_ushort v47, v50, s[48:49] offset:1024 sc1
global_load_ushort v48, v50, s[48:49] offset:2048 sc1
global_load_ushort v49, v50, s[48:49] offset:3072 sc1
s_add_u32 s56, s56, 1
s_cmp_ge_u32 s56, 40000
s_cbranch_scc1 Lrd_64
s_waitcnt vmcnt(0)
v_max3_u32 v51, v42, v43, v44
v_max3_u32 v51, v51, v45, v46
v_max3_u32 v51, v51, v47, v48
v_max_u32 v51, v51, v49
v_cmp_eq_u32 vcc, 0xffff, v51
s_cbranch_vccnz Lrv_63
Lrd_64:
s_waitcnt vmcnt(0)
v_lshlrev_b32 v42, 16, v42
v_lshlrev_b32 v43, 16, v43
v_lshlrev_b32 v44, 16, v44
v_lshlrev_b32 v45, 16, v45
v_lshlrev_b32 v46, 16, v46
v_lshlrev_b32 v47, 16, v47
v_lshlrev_b32 v48, 16, v48
v_lshlrev_b32 v49, 16, v49
v_add_f32 v42, v42, v43
v_add_f32 v44, v44, v45
v_add_f32 v46, v46, v47
v_add_f32 v48, v48, v49
v_add_f32 v42, v42, v44
v_add_f32 v46, v46, v48
v_add_f32 v17, v42, v46
Lrs_62:
Lw_61:
v_mov_b32 v32, 0
v_mov_b32 v33, 0
v_mov_b32 v34, 0
v_mov_b32 v35, 0
s_cmp_eq_u32 s6, 3
s_cbranch_scc1 Lxd_65
s_sleep 4
Lxd_65:
s_add_u32 s48, s46, 425984
s_addc_u32 s49, s47, 0
s_mov_b64 exec, s[42:43]
s_mov_b32 s56, 0
Lpoll_66:
global_load_dwordx4 v[32:35], v4, s[48:49] sc1
s_add_u32 s56, s56, 1
s_cmp_ge_u32 s56, 40000
s_cbranch_scc1 Lgot_67
s_waitcnt vmcnt(0)
v_max3_u32 v42, v32, v33, v34
v_max_u32 v42, v42, v35
v_cmp_eq_u32 vcc, -1, v42
s_cbranch_vccnz Lpoll_66
Lgot_67:
s_waitcnt vmcnt(0)
s_mov_b64 exec, -1
v_mfma_f32_16x16x32_bf16 v[64:67], v[32:35], v[160:163], 0
s_mov_b32 s8, 0xffff
s_mov_b32 s9, 0
v_mfma_f32_16x16x32_bf16 v[68:71], v[32:35], v[164:167], 0
v_mfma_f32_16x16x32_bf16 v[72:75], v[32:35], v[168:171], 0
v_mfma_f32_16x16x32_bf16 v[76:79], v[32:35], v[172:175], 0
v_mfma_f32_16x16x32_bf16 v[80:83], v[32:35], v[176:179], 0
v_mfma_f32_16x16x32_bf16 v[84:87], v[32:35], v[180:183], 0
v_mfma_f32_16x16x32_bf16 v[88:91], v[32:35], v[184:187], 0
v_mfma_f32_16x16x32_bf16 v[92:95], v[32:35], v[188:191], 0
s_nop 1
v_add_f32 v54, v64, v69
s_nop 0
v_add_f32 v55, v72, v77
s_nop 0
v_add_f32 v56, v80, v85
s_nop 0
v_add_f32 v57, v88, v93
s_mov_b64 exec, s[8:9]
ds_write_b128 v27, v[54:57]
s_mov_b64 exec, -1
s_waitcnt lgkmcnt(0)
s_barrier
s_cmp_lg_u32 s6, 3
s_cbranch_scc1 Lw_68
ds_read2st64_b32 v[42:43], v28 offset0:0 offset1:1
ds_read2st64_b32 v[44:45], v28 offset0:2 offset1:3
s_waitcnt lgkmcnt(0)
v_add_f32 v42, v42, v43
v_add_f32 v44, v44, v45
v_add_f32 v54, v42, v44
v_add_f32 v54, v54, v17
s_add_u32 s48, s46, 352256
s_addc_u32 s49, s47, 0
global_store_dword v12, v54, s[48:49] sc1
s_cmp_lg_u32 s3, 0
s_cbranch_scc1 Lz_69
v_mov_b32 v62, v12
s_sleep 6
s_mov_b32 s56, 0
Lpoll_70:
global_load_dword v64, v62, s[48:49] offset:0 sc1
global_load_dword v65, v62, s[48:49] offset:256 sc1
global_load_dword v66, v62, s[48:49] offset:512 sc1
global_load_dword v67, v62, s[48:49] offset:768 sc1
global_load_dword v68, v62, s[48:49] offset:1024 sc1
global_load_dword v69, v62, s[48:49] offset:1280 sc1
global_load_dword v70, v62, s[48:49] offset:1536 sc1
global_load_dword v71, v62, s[48:49] offset:1792 sc1
s_add_u32 s56, s56, 1
s_cmp_ge_u32 s56, 40000
s_cbranch_scc1 Lgot_71
s_waitcnt vmcnt(0)
v_max3_u32 v42, v64, v65, v66
v_max3_u32 v42, v42, v67, v68
v_max3_u32 v42, v42, v69, v70
v_max_u32 v42, v42, v71
v_cmp_eq_u32 vcc, -1, v42
s_cbranch_vccnz Lpoll_70
Lgot_71:
s_waitcnt vmcnt(0)
v_add_f32 v64, v64, v65
v_add_f32 v66, v66, v67
v_add_f32 v68, v68, v69
v_add_f32 v70, v70, v71
v_add_f32 v64, v64, v66
v_add_f32 v68, v68, v70
v_add_f32 v54, v64, v68
s_nop 1
v_mov_b32_dpp v43, v54 quad_perm:[1,1,3,3] row_mask:0xf bank_mask:0xf
v_cvt_pk_bf16_f32 v55, v54, v43
s_lshl_b32 s38, s4, 10
s_lshl_b32 s39, s5, 7
s_add_u32 s38, s38, s39
v_lshlrev_b32 v56, 1, v0
v_add_u32 v56, s38, v56
s_mov_b64 exec, s[50:51]
global_store_dword v56, v55, s[26:27]
s_mov_b64 exec, -1
Lz_69:
Lw_68:
L_end:
s_endpgm
L_text_end:
.section .rodata,"a"
.p2align 6
.amdhsa_kernel interleave_layers__sliding_block_cached__glu_gated_glu__decode_kernel
  .amdhsa_next_free_vgpr 512
  .amdhsa_next_free_sgpr 102
  .amdhsa_accum_offset 256
  .amdhsa_group_segment_fixed_size 0
  .amdhsa_kernarg_size 96
  .amdhsa_user_sgpr_count 2
  .amdhsa_user_sgpr_kernarg_segment_ptr 1
  .amdhsa_system_sgpr_workgroup_id_x 1
.end_amdhsa_kernel
```
